```python
import torch

def _softmax(x, axis=-1):
    return torch.softmax(x, dim=axis)
def _gelu(x):
    return torch.nn.functional.gelu(x, approximate="tanh")
def _silu(x):
    return torch.nn.functional.silu(x)
def _sigmoid(x):
    return torch.sigmoid(x)
def _layernorm(x, axis=-1, eps=1e-5):
    m = x.mean(dim=axis, keepdim=True)
    v = x.var(dim=axis, keepdim=True, unbiased=False)
    return (x - m) / torch.sqrt(v + eps)
def _scatter_add(tgt, idx, src, axis=0):
    return tgt.clone().index_add_(axis, idx, src)
def _segment_sum(src, seg, n):
    out = torch.zeros((n,) + src.shape[1:], dtype=src.dtype)
    return out.index_add_(0, seg, src)
def _pad(x, pw):
    flat = tuple(v for pair in reversed(pw) for v in pair)
    return torch.nn.functional.pad(x, flat)

kernel_name = 'concat_heads__mha_block_cached__mha_block_cached__near_ridge'

def setup_inputs():

    _w = (lambda a: (lambda t: t.to(torch.bfloat16) if t.is_floating_point() else t)(torch.as_tensor(a)))
    def _A_setup():
        B, Sq, D = 8, 144, 1024
        H, Sk, Dh = 32, 512, 128
        return {
            "x": _w((lambda *s: torch.randn(*s, dtype=torch.bfloat16) * 0.8)(B, Sq, D)),
            "k_cache": _w((lambda *s: torch.randn(*s, dtype=torch.bfloat16) * 0.8)(B, H, Sk, Dh)),
            "v_cache": _w((lambda *s: torch.randn(*s, dtype=torch.bfloat16) * 0.05)(B, H, Sk, Dh)),
            "wq": _w((lambda *s: torch.randn(*s, dtype=torch.bfloat16) * 0.8)(D, H * Dh) * (D ** -0.5)),
            "wo": _w((lambda *s: torch.randn(*s, dtype=torch.bfloat16) * 0.05)(H * Dh, D) * ((H * Dh) ** -0.5)),
        }
    _A_in = _A_setup()

    def _B_setup():
        B, Sq, D = 8, 144, 1024
        H, Sk, Dh = 32, 512, 128
        return {
            "x": _w((lambda *s: torch.randn(*s, dtype=torch.bfloat16) * 0.8)(B, Sq, D)),
            "k_cache": _w((lambda *s: torch.randn(*s, dtype=torch.bfloat16) * 0.8)(B, H, Sk, Dh)),
            "v_cache": _w((lambda *s: torch.randn(*s, dtype=torch.bfloat16) * 0.05)(B, H, Sk, Dh)),
            "wq": _w((lambda *s: torch.randn(*s, dtype=torch.bfloat16) * 0.8)(D, H * Dh) * (D ** -0.5)),
            "wo": _w((lambda *s: torch.randn(*s, dtype=torch.bfloat16) * 0.05)(H * Dh, D) * ((H * Dh) ** -0.5)),
        }
    _B_in = _B_setup()

    return {
        "A_x": _A_in["x"],
        "A_k_cache": _A_in["k_cache"],
        "A_v_cache": _A_in["v_cache"],
        "A_wq": _A_in["wq"],
        "A_wo": _A_in["wo"],
        "B_x": _B_in["x"],
        "B_k_cache": _B_in["k_cache"],
        "B_v_cache": _B_in["v_cache"],
        "B_wq": _B_in["wq"],
        "B_wo": _B_in["wo"],
    }

def reference(A_x, A_k_cache, A_v_cache, A_wq, A_wo, B_x, B_k_cache, B_v_cache, B_wq, B_wo):
    def _A_ref(x, k_cache, v_cache, wq, wo):
        B, Sq, D = x.shape
        H, Dh = 32, 128
        q = (lambda x, *d: x.permute(*d))((x @ wq).reshape(B, Sq, H, Dh), 0, 2, 1, 3)
        scores = torch.einsum("bhqd,bhkd->bhqk", q, k_cache) * (Dh ** -0.5)
        p = _softmax(scores, axis=-1)
        o = torch.einsum("bhqk,bhkd->bhqd", p, v_cache)
        return (lambda x, *d: x.permute(*d))(o, 0, 2, 1, 3).reshape(B, Sq, H * Dh) @ wo

    def _B_ref(x, k_cache, v_cache, wq, wo):
        B, Sq, D = x.shape
        H, Dh = 32, 128
        q = (lambda x, *d: x.permute(*d))((x @ wq).reshape(B, Sq, H, Dh), 0, 2, 1, 3)
        scores = torch.einsum("bhqd,bhkd->bhqk", q, k_cache) * (Dh ** -0.5)
        p = _softmax(scores, axis=-1)
        o = torch.einsum("bhqk,bhkd->bhqd", p, v_cache)
        return (lambda x, *d: x.permute(*d))(o, 0, 2, 1, 3).reshape(B, Sq, H * Dh) @ wo

    a = _A_ref(A_x, A_k_cache, A_v_cache, A_wq, A_wo)
    b = _B_ref(B_x, B_k_cache, B_v_cache, B_wq, B_wo)
    return torch.concatenate([a, b], axis=-1)
```

```asm
; @launch grid=(256,1,1) block=(512,1,1) lds=163840
.amdgcn_target "amdgcn-amd-amdhsa--gfx950"
.text
.globl concat_heads__mha_block_cached__mha_block_cached__near_ridge_kernel
.p2align 8
.type concat_heads__mha_block_cached__mha_block_cached__near_ridge_kernel,@function
concat_heads__mha_block_cached__mha_block_cached__near_ridge_kernel:
    s_cmp_ge_u32 s2, 256
    s_cbranch_scc1 k1_end
    s_and_b32 s3, s2, 7
    s_lshr_b32 s4, s2, 3
    s_lshr_b32 s43, s3, 2
    s_mul_i32 s5, s43, 40
    s_load_dwordx8 s[8:15], s[0:1], s5
    s_load_dwordx2 s[16:17], s[0:1], 96
    s_add_u32 s5, s5, 32
    s_load_dwordx2 s[18:19], s[0:1], s5
    s_load_dwordx2 s[100:101], s[0:1], 88
    s_and_b32 s5, s4, 3
    s_lshl_b32 s6, s5, 1
    s_add_u32 s3, s3, s6
    s_and_b32 s3, s3, 3
    s_lshl_b32 s45, s5, 2
    s_add_u32 s45, s45, s3
    s_lshr_b32 s44, s4, 2
    s_add_u32 s75, s44, s5
    v_lshrrev_b32 v14, 6, v0
    s_nop 0
    v_readfirstlane_b32 s40, v14
    v_and_b32 v0, 63, v0
    s_and_b32 s41, s40, 3
    s_lshr_b32 s42, s40, 2
    s_lshr_b32 s3, s41, 1
    s_xor_b32 s61, s41, s3
    s_and_b32 s61, s61, 1
    s_lshl_b32 s61, s61, 1
    s_or_b32 s61, s61, s3
    v_and_b32 v14, 7, v0
    v_xor_b32 v14, s61, v14
    v_bfe_u32 v15, v0, 4, 1
    v_lshlrev_b32 v15, 2, v15
    v_xor_b32 v14, v14, v15
    v_lshlrev_b32 v14, 4, v14
    v_lshrrev_b32 v15, 5, v0
    v_lshl_add_u32 v14, v15, 7, v14
    v_lshrrev_b32 v12, 4, v0
    v_bfe_u32 v15, v0, 3, 2
    s_lshl_b32 s3, s41, 4
    v_add_u32 v15, s3, v15
    v_lshl_add_u32 v7, v15, 8, v14
    s_lshl_b32 s46, s41, 12
    s_cmp_eq_u32 s42, 0
    s_cbranch_scc1 k1_comp
    v_lshl_add_u32 v20, v15, 13, v14
    v_add_u32 v21, 31744, v20
    v_add_u32 v22, 63488, v20
    v_add_u32 v23, 95232, v20
    s_lshr_b32 s74, s2, 0
    s_and_b32 s74, s74, 0
    s_add_u32 s49, s74, s75
    s_and_b32 s49, s49, 0
    s_lshl_b32 s48, s49, 19
    s_lshl_b32 s3, s45, 9
    s_sub_u32 s26, 8388608, s3
    s_mov_b32 s27, 0x20000
    s_mov_b32 m0, s46
    s_waitcnt lgkmcnt(0)
    s_add_u32 s24, s14, s3
    s_addc_u32 s25, s15, 0
    buffer_load_dwordx4 v20, s[24:27], s48 offen offset:0 lds
    buffer_load_dwordx4 v21, s[24:27], s48 offen offset:1024 lds
    buffer_load_dwordx4 v22, s[24:27], s48 offen offset:2048 lds
    buffer_load_dwordx4 v23, s[24:27], s48 offen offset:3072 lds
    s_mul_i32 s3, s44, 294912
    s_add_u32 m0, s46, 114432
    s_nop 0
    buffer_load_dwordx4 v20, s[24:27], s48 offen offset:256 lds
    buffer_load_dwordx4 v21, s[24:27], s48 offen offset:1280 lds
    buffer_load_dwordx4 v22, s[24:27], s48 offen offset:2304 lds
    buffer_load_dwordx4 v23, s[24:27], s48 offen offset:3328 lds
    s_add_u32 s20, s8, s3
    s_addc_u32 s21, s9, 0
    s_mov_b32 s22, 294912
    s_mov_b32 s23, 0x20000
    v_and_b32 v15, 2, v12
    v_lshlrev_b32 v15, 1, v15
    v_xor_b32 v14, v12, v15
    v_and_b32 v15, 7, v0
    v_xor_b32 v14, v14, v15
    v_lshlrev_b32 v14, 4, v14
    v_lshrrev_b32 v15, 3, v0
    v_lshl_add_u32 v14, v15, 11, v14
    v_xor_b32 v15, 64, v14
    s_lshl_b32 s3, s41, 16
    v_add_u32 v24, s3, v14
    s_add_u32 s3, s3, 15360
    v_add_u32 v25, s3, v15
    s_add_u32 s3, s3, 15360
    v_add_u32 v26, s3, v14
    s_add_u32 s3, s3, 15360
    v_add_u32 v27, s3, v15
    s_lshl_b32 s3, s41, 6
    v_xor_b32 v14, s3, v14
    s_lshl_b32 s3, s41, 14
    s_add_u32 s3, s3, 262144
    v_add_u32 v28, s3, v14
    s_lshl_b32 s47, s41, 10
    s_add_u32 s47, s47, 65536
    s_add_u32 s74, s74, 1
    s_mov_b32 s53, 0
    s_mov_b32 s54, 0
    s_add_u32 s56, s46, s54
    s_add_u32 m0, s56, 49152
    s_lshl_b32 s49, s49, 7
    buffer_load_dwordx4 v24, s[20:23], s49 offen offset:0 lds
    buffer_load_dwordx4 v25, s[20:23], s49 offen offset:1024 lds
    buffer_load_dwordx4 v26, s[20:23], s49 offen offset:2048 lds
    buffer_load_dwordx4 v27, s[20:23], s49 offen offset:3072 lds
    s_add_u32 m0, s47, s54
    s_cmp_ge_u32 s41, 2
    s_cbranch_scc1 k1_skipx_1
    buffer_load_dwordx4 v28, s[20:23], s49 offen lds
k1_skipx_1:
    s_add_u32 s53, s53, 16384
    s_add_u32 s54, s54, 18432
    s_cmp_eq_u32 s53, 49152
    s_cselect_b32 s53, 0, s53
    s_cselect_b32 s54, 0, s54
    s_mul_i32 s60, s42, 81920
    s_add_u32 s60, s60, s46
    s_lshl_b32 s3, s44, 4
    s_add_u32 s3, s3, s45
    s_lshl_b32 s3, s3, 18
    s_add_u32 s28, s10, s3
    s_addc_u32 s29, s11, 0
    s_mov_b32 s30, 262144
    s_mov_b32 s31, 0x20000
    s_add_u32 s32, s12, s3
    s_addc_u32 s33, s13, 0
    s_mov_b32 s34, 262144
    s_mov_b32 s35, 0x20000
    s_cmp_ge_u32 s74, 6
    s_cselect_b32 s49, s75, 0
    s_add_u32 s49, s74, s49
    s_and_b32 s49, s49, 1
    s_and_b32 s48, s74, 14
    s_or_b32 s49, s49, s48
    s_add_u32 m0, s46, s53
    s_lshl_b32 s48, s49, 19
    s_add_u32 s74, s74, 1
    buffer_load_dwordx4 v20, s[24:27], s48 offen offset:0 lds
    buffer_load_dwordx4 v21, s[24:27], s48 offen offset:1024 lds
    buffer_load_dwordx4 v22, s[24:27], s48 offen offset:2048 lds
    buffer_load_dwordx4 v23, s[24:27], s48 offen offset:3072 lds
    s_add_u32 m0, m0, 114432
    s_nop 0
    buffer_load_dwordx4 v20, s[24:27], s48 offen offset:256 lds
    buffer_load_dwordx4 v21, s[24:27], s48 offen offset:1280 lds
    buffer_load_dwordx4 v22, s[24:27], s48 offen offset:2304 lds
    buffer_load_dwordx4 v23, s[24:27], s48 offen offset:3328 lds
    s_waitcnt vmcnt(8)
    s_barrier
    s_add_u32 s56, s46, s54
    s_add_u32 m0, s56, 49152
    s_lshl_b32 s49, s49, 7
    buffer_load_dwordx4 v24, s[20:23], s49 offen offset:0 lds
    buffer_load_dwordx4 v25, s[20:23], s49 offen offset:1024 lds
    buffer_load_dwordx4 v26, s[20:23], s49 offen offset:2048 lds
    buffer_load_dwordx4 v27, s[20:23], s49 offen offset:3072 lds
    s_add_u32 m0, s47, s54
    s_cmp_ge_u32 s41, 2
    s_cbranch_scc1 k1_skipx_2
    buffer_load_dwordx4 v28, s[20:23], s49 offen lds
k1_skipx_2:
    s_add_u32 s53, s53, 16384
    s_add_u32 s54, s54, 18432
    s_cmp_eq_u32 s53, 49152
    s_cselect_b32 s53, 0, s53
    s_cselect_b32 s54, 0, s54
    s_cmp_ge_u32 s74, 6
    s_cselect_b32 s49, s75, 0
    s_add_u32 s49, s74, s49
    s_and_b32 s49, s49, 1
    s_and_b32 s48, s74, 14
    s_or_b32 s49, s49, s48
    s_add_u32 m0, s46, s53
    s_lshl_b32 s48, s49, 19
    s_add_u32 s74, s74, 1
    buffer_load_dwordx4 v20, s[24:27], s48 offen offset:0 lds
    buffer_load_dwordx4 v21, s[24:27], s48 offen offset:1024 lds
    buffer_load_dwordx4 v22, s[24:27], s48 offen offset:2048 lds
    buffer_load_dwordx4 v23, s[24:27], s48 offen offset:3072 lds
    s_add_u32 m0, m0, 114432
    s_nop 0
    buffer_load_dwordx4 v20, s[24:27], s48 offen offset:256 lds
    buffer_load_dwordx4 v21, s[24:27], s48 offen offset:1280 lds
    buffer_load_dwordx4 v22, s[24:27], s48 offen offset:2304 lds
    buffer_load_dwordx4 v23, s[24:27], s48 offen offset:3328 lds
    s_add_u32 s56, s46, s54
    s_add_u32 m0, s56, 49152
    s_lshl_b32 s49, s49, 7
    buffer_load_dwordx4 v24, s[20:23], s49 offen offset:0 lds
    buffer_load_dwordx4 v25, s[20:23], s49 offen offset:1024 lds
    buffer_load_dwordx4 v26, s[20:23], s49 offen offset:2048 lds
    buffer_load_dwordx4 v27, s[20:23], s49 offen offset:3072 lds
    s_add_u32 m0, s47, s54
    s_cmp_ge_u32 s41, 2
    s_cbranch_scc1 k1_skipx_3
    buffer_load_dwordx4 v28, s[20:23], s49 offen lds
k1_skipx_3:
    s_add_u32 s53, s53, 16384
    s_add_u32 s54, s54, 18432
    s_cmp_eq_u32 s53, 49152
    s_cselect_b32 s53, 0, s53
    s_cselect_b32 s54, 0, s54
    s_cmp_lg_u32 s41, 0
    s_cbranch_scc1 k1_noreset
    s_add_u32 s36, s16, 50331648
    s_addc_u32 s37, s17, 0
    s_mov_b32 s38, 98304
    s_mov_b32 s39, 0x20000
    s_lshl_b32 s4, s43, 3
    s_add_u32 s4, s4, s44
    s_lshl_b32 s4, s4, 4
    s_add_u32 s4, s4, s45
    s_lshl_b32 s4, s4, 7
    s_add_u32 s4, s4, 65536
    s_lshl_b32 s3, s2, 8
    v_lshlrev_b32 v14, 2, v0
    v_and_b32 v16, 127, v14
    v_mov_b32 v15, 0
    buffer_store_dword v15, v14, s[36:39], s3 offen sc1
    buffer_store_dword v15, v16, s[36:39], s4 offen sc1
k1_noreset:
    s_mul_i32 s3, s2, 171
    s_lshr_b32 s3, s3, 9
    s_mul_i32 s3, s3, 3
    s_sub_u32 s51, s2, s3
    s_add_u32 s51, s51, 1
    s_mov_b32 s50, 0
    s_mov_b32 s52, 0
    s_mov_b32 s55, 0
k1_lloop:
    s_cmp_gt_i32 s50, 0
    s_cbranch_scc1 k1_loose_4
    s_waitcnt vmcnt(12)
k1_loose_4:
    s_sub_i32 s50, s50, 1
    s_waitcnt vmcnt(20)
    s_barrier
    s_cmp_ge_u32 s74, 6
    s_cselect_b32 s49, s75, 0
    s_add_u32 s49, s74, s49
    s_and_b32 s49, s49, 1
    s_and_b32 s48, s74, 14
    s_or_b32 s49, s49, s48
    s_add_u32 m0, s46, s53
    s_lshl_b32 s48, s49, 19
    s_add_u32 s74, s74, 1
    buffer_load_dwordx4 v20, s[24:27], s48 offen offset:0 lds
    buffer_load_dwordx4 v21, s[24:27], s48 offen offset:1024 lds
    buffer_load_dwordx4 v22, s[24:27], s48 offen offset:2048 lds
    buffer_load_dwordx4 v23, s[24:27], s48 offen offset:3072 lds
    s_add_u32 m0, m0, 114432
    s_nop 0
    buffer_load_dwordx4 v20, s[24:27], s48 offen offset:256 lds
    buffer_load_dwordx4 v21, s[24:27], s48 offen offset:1280 lds
    buffer_load_dwordx4 v22, s[24:27], s48 offen offset:2304 lds
    buffer_load_dwordx4 v23, s[24:27], s48 offen offset:3328 lds
    s_add_u32 s56, s46, s54
    s_add_u32 m0, s56, 49152
    s_lshl_b32 s49, s49, 7
    buffer_load_dwordx4 v24, s[20:23], s49 offen offset:0 lds
    buffer_load_dwordx4 v25, s[20:23], s49 offen offset:1024 lds
    buffer_load_dwordx4 v26, s[20:23], s49 offen offset:2048 lds
    buffer_load_dwordx4 v27, s[20:23], s49 offen offset:3072 lds
    s_add_u32 m0, s47, s54
    s_cmp_ge_u32 s41, 2
    s_cbranch_scc1 k1_skipx_5
    buffer_load_dwordx4 v28, s[20:23], s49 offen lds
k1_skipx_5:
    s_add_u32 s53, s53, 16384
    s_add_u32 s54, s54, 18432
    s_cmp_eq_u32 s53, 49152
    s_cselect_b32 s53, 0, s53
    s_cselect_b32 s54, 0, s54
    s_cmp_lg_u32 s55, s51
    s_cbranch_scc1 k1_kvdone
    s_add_u32 s51, s51, 3
    s_add_u32 s52, s52, 1
    s_cmp_lg_u32 s52, 1
    s_cbranch_scc1 k1_kv1
    s_mov_b32 s50, 2
    s_mov_b32 s56, 0
    buffer_load_dwordx4 v[160:163], v7, s[28:31], s56 offen offset:0 nt
    buffer_load_dwordx4 v[164:167], v7, s[28:31], s56 offen offset:1024 nt
    buffer_load_dwordx4 v[168:171], v7, s[28:31], s56 offen offset:2048 nt
    buffer_load_dwordx4 v[172:175], v7, s[28:31], s56 offen offset:3072 nt
    s_mov_b32 s56, 131072
    buffer_load_dwordx4 v[176:179], v7, s[28:31], s56 offen offset:0 nt
    buffer_load_dwordx4 v[180:183], v7, s[28:31], s56 offen offset:1024 nt
    buffer_load_dwordx4 v[184:187], v7, s[28:31], s56 offen offset:2048 nt
    buffer_load_dwordx4 v[188:191], v7, s[28:31], s56 offen offset:3072 nt
    s_branch k1_kvdone
k1_kv1:
    s_cmp_lg_u32 s52, 2
    s_cbranch_scc1 k1_kv2
    s_mov_b32 s50, 2
    s_mov_b32 s56, 0
    buffer_load_dwordx4 v[192:195], v7, s[32:35], s56 offen offset:0 nt
    buffer_load_dwordx4 v[196:199], v7, s[32:35], s56 offen offset:1024 nt
    buffer_load_dwordx4 v[200:203], v7, s[32:35], s56 offen offset:2048 nt
    buffer_load_dwordx4 v[204:207], v7, s[32:35], s56 offen offset:3072 nt
    s_mov_b32 s56, 131072
    buffer_load_dwordx4 v[208:211], v7, s[32:35], s56 offen offset:0 nt
    buffer_load_dwordx4 v[212:215], v7, s[32:35], s56 offen offset:1024 nt
    buffer_load_dwordx4 v[216:219], v7, s[32:35], s56 offen offset:2048 nt
    buffer_load_dwordx4 v[220:223], v7, s[32:35], s56 offen offset:3072 nt
    s_branch k1_kvdone
k1_kv2:
    s_cmp_lg_u32 s52, 3
    s_cbranch_scc1 k1_kv3
    s_mov_b32 s50, 2
    s_mov_b32 s56, 16384
    buffer_load_dwordx4 v[76:79], v7, s[28:31], s56 offen offset:0 nt
    buffer_load_dwordx4 v[80:83], v7, s[28:31], s56 offen offset:1024 nt
    buffer_load_dwordx4 v[84:87], v7, s[28:31], s56 offen offset:2048 nt
    buffer_load_dwordx4 v[88:91], v7, s[28:31], s56 offen offset:3072 nt
    s_mov_b32 s56, 147456
    buffer_load_dwordx4 v[92:95], v7, s[28:31], s56 offen offset:0 nt
    buffer_load_dwordx4 v[96:99], v7, s[28:31], s56 offen offset:1024 nt
    buffer_load_dwordx4 v[100:103], v7, s[28:31], s56 offen offset:2048 nt
    buffer_load_dwordx4 v[104:107], v7, s[28:31], s56 offen offset:3072 nt
    s_branch k1_kvdone
k1_kv3:
    s_cmp_lg_u32 s52, 4
    s_cbranch_scc1 k1_kv4
    s_mov_b32 s50, 2
    s_mov_b32 s56, 16384
    buffer_load_dwordx4 v[108:111], v7, s[32:35], s56 offen offset:0 nt
    buffer_load_dwordx4 v[112:115], v7, s[32:35], s56 offen offset:1024 nt
    buffer_load_dwordx4 v[116:119], v7, s[32:35], s56 offen offset:2048 nt
    buffer_load_dwordx4 v[120:123], v7, s[32:35], s56 offen offset:3072 nt
    s_mov_b32 s56, 147456
    buffer_load_dwordx4 v[124:127], v7, s[32:35], s56 offen offset:0 nt
    buffer_load_dwordx4 v[128:131], v7, s[32:35], s56 offen offset:1024 nt
    buffer_load_dwordx4 v[132:135], v7, s[32:35], s56 offen offset:2048 nt
    buffer_load_dwordx4 v[136:139], v7, s[32:35], s56 offen offset:3072 nt
k1_kv4:
k1_kvdone:
    s_add_u32 s55, s55, 1
    s_cmp_lt_u32 s55, 13
    s_cbranch_scc1 k1_lloop
    s_add_u32 s3, s46, 16384
    v_lshl_add_u32 v10, v0, 4, s3
    v_add_u32 v11, 114688, v10
    v_add_u32 v8, 65536, v10
    s_cmp_gt_i32 s50, 0
    s_cbranch_scc1 k1_loose_6
    s_waitcnt vmcnt(12)
k1_loose_6:
    s_sub_i32 s50, s50, 1
    s_waitcnt vmcnt(20)
    s_barrier
    v_lshlrev_b32 v15, 4, v0
    s_getpc_b64 s[36:37]
k1_pc:
    s_mov_b32 s38, k1_end-k1_pc
    s_mov_b32 s39, 0x20000
    s_lshr_b32 s3, s45, 2
    s_lshl_b32 s3, s3, 2
    s_add_u32 s3, s3, s41
    s_lshl_b32 s3, s3, 11
    buffer_load_dwordx4 v[228:231], v15, s[36:39], s3 offen offset:0
    buffer_load_dwordx4 v[228:231], v15, s[36:39], s3 offen offset:1024
    s_lshl_b32 s3, s44, 4
    s_add_u32 s3, s3, s45
    s_lshl_b32 s3, s3, 16
    s_add_u32 s20, s18, s3
    s_addc_u32 s21, s19, 0
    s_mov_b32 s22, 65536
    s_lshl_b32 s56, s41, 14
    buffer_load_dwordx4 v[224:227], v15, s[20:23], s56 offen offset:0
    buffer_load_dwordx4 v[224:227], v15, s[20:23], s56 offen offset:1024
    buffer_load_dwordx4 v[224:227], v15, s[20:23], s56 offen offset:2048
    buffer_load_dwordx4 v[224:227], v15, s[20:23], s56 offen offset:3072
    s_add_u32 s56, s56, 4096
    buffer_load_dwordx4 v[224:227], v15, s[20:23], s56 offen offset:0
    buffer_load_dwordx4 v[224:227], v15, s[20:23], s56 offen offset:1024
    buffer_load_dwordx4 v[224:227], v15, s[20:23], s56 offen offset:2048
    buffer_load_dwordx4 v[224:227], v15, s[20:23], s56 offen offset:3072
    ds_write_b128 v10, v[160:163] offset:0
    ds_write_b128 v10, v[164:167] offset:1024
    ds_write_b128 v10, v[168:171] offset:2048
    ds_write_b128 v10, v[172:175] offset:3072
    ds_write_b128 v11, v[176:179] offset:0
    ds_write_b128 v11, v[180:183] offset:1024
    ds_write_b128 v11, v[184:187] offset:2048
    ds_write_b128 v11, v[188:191] offset:3072
    s_waitcnt vmcnt(10)
    s_barrier
    s_add_u32 s56, s56, 4096
    buffer_load_dwordx4 v[224:227], v15, s[20:23], s56 offen offset:0
    buffer_load_dwordx4 v[224:227], v15, s[20:23], s56 offen offset:1024
    buffer_load_dwordx4 v[224:227], v15, s[20:23], s56 offen offset:2048
    buffer_load_dwordx4 v[224:227], v15, s[20:23], s56 offen offset:3072
    s_add_u32 s56, s56, 4096
    buffer_load_dwordx4 v[224:227], v15, s[20:23], s56 offen offset:0
    buffer_load_dwordx4 v[224:227], v15, s[20:23], s56 offen offset:1024
    buffer_load_dwordx4 v[224:227], v15, s[20:23], s56 offen offset:2048
    buffer_load_dwordx4 v[224:227], v15, s[20:23], s56 offen offset:3072
    ds_write_b128 v10, v[192:195] offset:16384
    ds_write_b128 v10, v[196:199] offset:17408
    ds_write_b128 v10, v[200:203] offset:18432
    ds_write_b128 v10, v[204:207] offset:19456
    ds_write_b128 v11, v[208:211] offset:16384
    ds_write_b128 v11, v[212:215] offset:17408
    ds_write_b128 v11, v[216:219] offset:18432
    ds_write_b128 v11, v[220:223] offset:19456
    s_barrier
    s_call_b64 s[6:7], k1_asetup
    v_mov_b64 v[148:149], 0
    v_mov_b64 v[150:151], 0
    v_mov_b64 v[152:153], 0
    v_mov_b64 v[154:155], 0
    v_mov_b64 v[156:157], 0
    v_mov_b64 v[158:159], 0
    v_mov_b64 v[160:161], 0
    v_mov_b64 v[162:163], 0
    v_mov_b64 v[164:165], 0
    v_mov_b64 v[166:167], 0
    v_mov_b64 v[168:169], 0
    v_mov_b64 v[170:171], 0
    v_mov_b64 v[172:173], 0
    v_mov_b64 v[174:175], 0
    v_mov_b64 v[176:177], 0
    v_mov_b64 v[178:179], 0
    v_mov_b64 v[180:181], 0
    v_mov_b64 v[182:183], 0
    v_mov_b64 v[184:185], 0
    v_mov_b64 v[186:187], 0
    v_mov_b64 v[188:189], 0
    v_mov_b64 v[190:191], 0
    v_mov_b64 v[192:193], 0
    v_mov_b64 v[194:195], 0
    v_mov_b64 v[196:197], 0
    v_mov_b64 v[198:199], 0
    v_mov_b64 v[200:201], 0
    v_mov_b64 v[202:203], 0
    v_mov_b64 v[204:205], 0
    v_mov_b64 v[206:207], 0
    v_mov_b64 v[208:209], 0
    v_mov_b64 v[210:211], 0
    v_mov_b64 v[212:213], 0
    v_mov_b64 v[214:215], 0
    v_mov_b64 v[216:217], 0
    v_mov_b64 v[218:219], 0
    v_mov_b64 v[220:221], 0
    v_mov_b64 v[222:223], 0
    v_mov_b64 v[232:233], 0
    v_mov_b64 v[234:235], 0
    v_mov_b64 v[236:237], 0
    v_mov_b64 v[238:239], 0
    v_mov_b64 v[240:241], 0
    v_mov_b64 v[242:243], 0
    v_mov_b64 v[244:245], 0
    v_mov_b64 v[246:247], 0
    v_mov_b64 v[248:249], 0
    v_mov_b64 v[250:251], 0
    v_mov_b64 v[252:253], 0
    v_mov_b64 v[254:255], 0
    s_waitcnt vmcnt(0)
    v_mov_b64 v[224:225], 0
    v_mov_b64 v[226:227], 0
    v_mov_b64 v[228:229], 0
    v_mov_b64 v[230:231], 0
    s_cmp_lg_u32 s41, 0
    s_cbranch_scc1 k1_nocount
    s_mov_b32 s36, s100
    s_mov_b32 s37, s101
    s_mov_b32 s38, 256
    s_mov_b32 s39, 0x20000
    v_mov_b32 v140, 0
    v_mov_b32 v141, 1
    s_mov_b64 exec, 1
    buffer_atomic_add v141, v140, s[36:39], 0 offen sc1
    s_mov_b64 exec, -1
k1_nocount:
    s_branch k1_join
k1_asetup:
    s_lshl_b32 s58, s42, 15
    s_add_u32 s58, s58, 16384
    s_add_u32 s59, s58, 16384
    s_and_b32 s3, s41, 1
    s_lshl_b32 s3, s3, 11
    s_lshl_b32 s47, s3, 1
    s_sub_u32 s47, 2048, s47
    s_mul_i32 s5, s42, 81920
    s_add_u32 s5, s5, s3
    s_add_u32 s4, s5, s59
    s_add_u32 s5, s5, s58
    s_mul_i32 s3, s42, 36864
    s_add_u32 s3, s3, 49152
    v_lshl_add_u32 v11, v0, 4, s3
    s_lshl_b32 s3, s41, 13
    v_add_u32 v9, s3, v11
    v_lshrrev_b32 v12, 4, v0
    v_lshrrev_b32 v15, 1, v12
    v_xor_b32 v14, v12, v15
    v_and_b32 v14, 1, v14
    v_lshl_or_b32 v14, v14, 1, v15
    v_bfe_u32 v15, v0, 1, 1
    v_xor_b32 v14, v14, v15
    v_lshlrev_b32 v14, 4, v14
    v_lshl_add_u32 v14, v12, 12, v14
    v_bfe_u32 v15, v0, 2, 2
    v_lshl_add_u32 v14, v15, 7, v14
    v_bfe_u32 v15, v0, 3, 1
    v_lshl_add_u32 v14, v15, 6, v14
    v_and_b32 v15, 1, v0
    v_lshl_add_u32 v3, v15, 3, v14
    v_add_u32 v3, s4, v3
    v_xor_b32 v4, 32, v3
    v_xor_b32 v5, 64, v3
    v_xor_b32 v6, 96, v3
    v_bfe_u32 v13, v0, 2, 2
    v_lshrrev_b32 v15, 1, v13
    v_xor_b32 v14, v13, v15
    v_and_b32 v14, 1, v14
    v_lshl_or_b32 v14, v14, 1, v15
    v_xor_b32 v14, v14, v12
    v_lshlrev_b32 v14, 4, v14
    v_lshl_add_u32 v14, v13, 12, v14
    v_and_b32 v15, 3, v0
    v_lshl_add_u32 v14, v15, 7, v14
    v_bfe_u32 v15, v0, 1, 1
    v_lshl_add_u32 v14, v15, 6, v14
    v_add_u32 v1, s5, v14
    v_xor_b32 v2, 64, v1
    v_mov_b32 v12, 0x3f803f80
    v_mov_b32 v13, 0x3f803f80
    v_mov_b32 v14, 0x3f803f80
    v_mov_b32 v15, 0x3f803f80
    v_mov_b64 v[16:17], 0
    v_mov_b64 v[18:19], 0
    v_mov_b64 v[20:21], 0
    v_mov_b64 v[22:23], 0
    v_mov_b64 v[24:25], 0
    v_mov_b64 v[26:27], 0
    s_mov_b32 s66, 0xff61b1e6
    s_mov_b32 s67, 0xff61b1e6
    s_mov_b32 s68, 0xff61b1e6
    s_mov_b32 s69, 0xff61b1e6
    s_lshl_b32 s3, s42, 17
    v_add_u32 v7, s3, v7
    s_mov_b32 s64, 32768
    s_mov_b32 s65, 32768
    s_mov_b32 s57, 32768
    s_mov_b32 s46, 0
    s_setpc_b64 s[6:7]
k1_comp:
    v_lshrrev_b32 v12, 4, v0
    v_lshrrev_b32 v15, 1, v12
    v_xor_b32 v14, v12, v15
    v_and_b32 v14, 1, v14
    v_lshl_or_b32 v14, v14, 1, v15
    v_bfe_u32 v15, v0, 1, 1
    v_xor_b32 v14, v14, v15
    v_lshlrev_b32 v14, 4, v14
    v_lshl_add_u32 v14, v12, 12, v14
    v_bfe_u32 v15, v0, 2, 2
    v_lshl_add_u32 v14, v15, 7, v14
    v_bfe_u32 v15, v0, 3, 1
    v_lshl_add_u32 v14, v15, 6, v14
    v_and_b32 v15, 1, v0
    v_lshl_add_u32 v28, v15, 3, v14
    s_lshr_b32 s3, s41, 1
    s_mul_i32 s4, s3, 114688
    s_and_b32 s5, s41, 1
    s_lshl_b32 s6, s5, 9
    s_add_u32 s4, s4, s6
    v_add_u32 v28, s4, v28
    v_xor_b32 v29, 32, v28
    v_xor_b32 v30, 64, v28
    v_xor_b32 v31, 96, v28
    v_and_b32 v13, 15, v0
    v_lshrrev_b32 v14, 1, v13
    v_and_b32 v15, 2, v14
    v_lshlrev_b32 v15, 1, v15
    v_xor_b32 v14, v14, v15
    v_lshlrev_b32 v15, 1, v12
    v_xor_b32 v14, v14, v15
    v_lshlrev_b32 v14, 4, v14
    v_lshl_add_u32 v14, v13, 7, v14
    v_add_u32 v32, 49152, v14
    v_xor_b32 v33, 16, v32
    s_mul_i32 s4, s3, 36864
    s_lshl_b32 s6, s5, 11
    s_add_u32 s4, s4, s6
    s_add_u32 s4, s4, 49152
    v_lshl_add_u32 v14, v13, 4, s4
    v_lshrrev_b32 v15, 1, v12
    v_lshl_add_u32 v14, v15, 8, v14
    v_and_b32 v15, 1, v12
    v_lshl_add_u32 v34, v15, 3, v14
    s_waitcnt lgkmcnt(0)
    s_mul_i32 s60, s42, 81920
    s_add_u32 s60, s60, s46
    s_lshl_b32 s3, s44, 4
    s_add_u32 s3, s3, s45
    s_lshl_b32 s3, s3, 18
    s_add_u32 s28, s10, s3
    s_addc_u32 s29, s11, 0
    s_mov_b32 s30, 262144
    s_mov_b32 s31, 0x20000
    s_add_u32 s32, s12, s3
    s_addc_u32 s33, s13, 0
    s_mov_b32 s34, 262144
    s_mov_b32 s35, 0x20000
    s_call_b64 s[6:7], k1_asetup
    s_mov_b32 s70, 0x3e0293ee
    s_mov_b32 s71, 0x3e0293ee
    v_mov_b64 v[112:113], 0
    v_mov_b64 v[114:115], 0
    v_mov_b64 v[116:117], 0
    v_mov_b64 v[118:119], 0
    v_mov_b64 v[120:121], 0
    v_mov_b64 v[122:123], 0
    v_mov_b64 v[124:125], 0
    v_mov_b64 v[126:127], 0
    v_mov_b64 v[128:129], 0
    v_mov_b64 v[130:131], 0
    v_mov_b64 v[132:133], 0
    v_mov_b64 v[134:135], 0
    v_mov_b64 v[136:137], 0
    v_mov_b64 v[138:139], 0
    v_mov_b64 v[140:141], 0
    v_mov_b64 v[142:143], 0
    v_mov_b64 v[144:145], 0
    v_mov_b64 v[146:147], 0
    v_mov_b64 v[148:149], 0
    v_mov_b64 v[150:151], 0
    v_mov_b64 v[152:153], 0
    v_mov_b64 v[154:155], 0
    v_mov_b64 v[156:157], 0
    v_mov_b64 v[158:159], 0
    v_mov_b64 v[160:161], 0
    v_mov_b64 v[162:163], 0
    v_mov_b64 v[164:165], 0
    v_mov_b64 v[166:167], 0
    v_mov_b64 v[168:169], 0
    v_mov_b64 v[170:171], 0
    v_mov_b64 v[172:173], 0
    v_mov_b64 v[174:175], 0
    v_mov_b64 v[176:177], 0
    v_mov_b64 v[178:179], 0
    v_mov_b64 v[180:181], 0
    v_mov_b64 v[182:183], 0
    v_mov_b64 v[184:185], 0
    v_mov_b64 v[186:187], 0
    v_mov_b64 v[188:189], 0
    v_mov_b64 v[190:191], 0
    v_mov_b64 v[192:193], 0
    v_mov_b64 v[194:195], 0
    v_mov_b64 v[196:197], 0
    v_mov_b64 v[198:199], 0
    v_mov_b64 v[200:201], 0
    v_mov_b64 v[202:203], 0
    v_mov_b64 v[204:205], 0
    v_mov_b64 v[206:207], 0
    v_mov_b64 v[208:209], 0
    v_mov_b64 v[210:211], 0
    v_mov_b64 v[212:213], 0
    v_mov_b64 v[214:215], 0
    v_mov_b64 v[216:217], 0
    v_mov_b64 v[218:219], 0
    v_mov_b64 v[220:221], 0
    v_mov_b64 v[222:223], 0
    v_mov_b64 v[224:225], 0
    v_mov_b64 v[226:227], 0
    v_mov_b64 v[228:229], 0
    v_mov_b64 v[230:231], 0
    v_mov_b64 v[232:233], 0
    v_mov_b64 v[234:235], 0
    v_mov_b64 v[236:237], 0
    v_mov_b64 v[238:239], 0
    v_mov_b64 v[240:241], 0
    v_mov_b64 v[242:243], 0
    v_mov_b64 v[244:245], 0
    v_mov_b64 v[246:247], 0
    v_mov_b64 v[248:249], 0
    v_mov_b64 v[250:251], 0
    v_mov_b64 v[252:253], 0
    v_mov_b64 v[254:255], 0
    s_setprio 1
    s_barrier
    ds_read_b64_tr_b16 v[44:45], v28 offset:0
    ds_read_b64_tr_b16 v[46:47], v28 offset:1024
    ds_read_b64_tr_b16 v[48:49], v29 offset:0
    ds_read_b64_tr_b16 v[50:51], v29 offset:1024
    ds_read_b64_tr_b16 v[52:53], v30 offset:0
    ds_read_b64_tr_b16 v[54:55], v30 offset:1024
    ds_read_b64_tr_b16 v[56:57], v31 offset:0
    ds_read_b64_tr_b16 v[58:59], v31 offset:1024
    ds_read_b128 v[76:79], v32 offset:0
    ds_read_b128 v[80:83], v32 offset:2048
    ds_read_b128 v[84:87], v32 offset:4096
    ds_read_b128 v[88:91], v32 offset:6144
    ds_read_b128 v[92:95], v32 offset:8192
    ds_read_b128 v[96:99], v32 offset:10240
    ds_read_b128 v[100:103], v32 offset:12288
    ds_read_b128 v[104:107], v32 offset:14336
    ds_read_b128 v[108:111], v32 offset:16384
    s_mov_b32 s55, 0
    s_waitcnt lgkmcnt(0)
k1_qloop:
    s_waitcnt lgkmcnt(13)
    v_mfma_f32_16x16x32_bf16 v[112:115], v[44:47], v[76:79], v[112:115]
    ds_read_b64_tr_b16 v[60:61], v28 offset:2048
    s_waitcnt lgkmcnt(11)
    v_mfma_f32_16x16x32_bf16 v[116:119], v[48:51], v[76:79], v[116:119]
    s_waitcnt lgkmcnt(8)
    v_mfma_f32_16x16x32_bf16 v[120:123], v[52:55], v[76:79], v[120:123]
    ds_read_b64_tr_b16 v[62:63], v28 offset:3072
    s_waitcnt lgkmcnt(6)
    v_mfma_f32_16x16x32_bf16 v[124:127], v[56:59], v[76:79], v[124:127]
    ds_read_b128 v[76:79], v33 offset:0
    v_mfma_f32_16x16x32_bf16 v[128:131], v[44:47], v[80:83], v[128:131]
    ds_read_b64_tr_b16 v[64:65], v29 offset:2048
    v_mfma_f32_16x16x32_bf16 v[132:135], v[48:51], v[80:83], v[132:135]
    v_mfma_f32_16x16x32_bf16 v[136:139], v[52:55], v[80:83], v[136:139]
    ds_read_b64_tr_b16 v[66:67], v29 offset:3072
    v_mfma_f32_16x16x32_bf16 v[140:143], v[56:59], v[80:83], v[140:143]
    ds_read_b128 v[80:83], v33 offset:2048
    v_mfma_f32_16x16x32_bf16 v[144:147], v[44:47], v[84:87], v[144:147]
    ds_read_b64_tr_b16 v[68:69], v30 offset:2048
    v_mfma_f32_16x16x32_bf16 v[148:151], v[48:51], v[84:87], v[148:151]
    v_mfma_f32_16x16x32_bf16 v[152:155], v[52:55], v[84:87], v[152:155]
    ds_read_b64_tr_b16 v[70:71], v30 offset:3072
    v_mfma_f32_16x16x32_bf16 v[156:159], v[56:59], v[84:87], v[156:159]
    ds_read_b128 v[84:87], v33 offset:4096
    v_mfma_f32_16x16x32_bf16 v[160:163], v[44:47], v[88:91], v[160:163]
    ds_read_b64_tr_b16 v[72:73], v31 offset:2048
    v_mfma_f32_16x16x32_bf16 v[164:167], v[48:51], v[88:91], v[164:167]
    v_mfma_f32_16x16x32_bf16 v[168:171], v[52:55], v[88:91], v[168:171]
    ds_read_b64_tr_b16 v[74:75], v31 offset:3072
    v_mfma_f32_16x16x32_bf16 v[172:175], v[56:59], v[88:91], v[172:175]
    ds_read_b128 v[88:91], v33 offset:6144
    v_mfma_f32_16x16x32_bf16 v[176:179], v[44:47], v[92:95], v[176:179]
    v_mfma_f32_16x16x32_bf16 v[180:183], v[48:51], v[92:95], v[180:183]
    v_mfma_f32_16x16x32_bf16 v[184:187], v[52:55], v[92:95], v[184:187]
    v_mfma_f32_16x16x32_bf16 v[188:191], v[56:59], v[92:95], v[188:191]
    ds_read_b128 v[92:95], v33 offset:8192
    s_waitcnt lgkmcnt(15)
    v_mfma_f32_16x16x32_bf16 v[192:195], v[44:47], v[96:99], v[192:195]
    v_mfma_f32_16x16x32_bf16 v[196:199], v[48:51], v[96:99], v[196:199]
    v_mfma_f32_16x16x32_bf16 v[200:203], v[52:55], v[96:99], v[200:203]
    v_mfma_f32_16x16x32_bf16 v[204:207], v[56:59], v[96:99], v[204:207]
    ds_read_b128 v[96:99], v33 offset:10240
    v_mfma_f32_16x16x32_bf16 v[208:211], v[44:47], v[100:103], v[208:211]
    v_mfma_f32_16x16x32_bf16 v[212:215], v[48:51], v[100:103], v[212:215]
    v_mfma_f32_16x16x32_bf16 v[216:219], v[52:55], v[100:103], v[216:219]
    v_mfma_f32_16x16x32_bf16 v[220:223], v[56:59], v[100:103], v[220:223]
    ds_read_b128 v[100:103], v33 offset:12288
    s_waitcnt lgkmcnt(15)
    v_mfma_f32_16x16x32_bf16 v[224:227], v[44:47], v[104:107], v[224:227]
    v_mfma_f32_16x16x32_bf16 v[228:231], v[48:51], v[104:107], v[228:231]
    v_mfma_f32_16x16x32_bf16 v[232:235], v[52:55], v[104:107], v[232:235]
    v_mfma_f32_16x16x32_bf16 v[236:239], v[56:59], v[104:107], v[236:239]
    ds_read_b128 v[104:107], v33 offset:14336
    v_mfma_f32_16x16x32_bf16 v[240:243], v[44:47], v[108:111], v[240:243]
    v_mfma_f32_16x16x32_bf16 v[244:247], v[48:51], v[108:111], v[244:247]
    v_mfma_f32_16x16x32_bf16 v[248:251], v[52:55], v[108:111], v[248:251]
    v_mfma_f32_16x16x32_bf16 v[252:255], v[56:59], v[108:111], v[252:255]
    ds_read_b128 v[108:111], v33 offset:16384
    s_waitcnt lgkmcnt(14)
    v_mfma_f32_16x16x32_bf16 v[112:115], v[60:63], v[76:79], v[112:115]
    s_waitcnt lgkmcnt(12)
    v_mfma_f32_16x16x32_bf16 v[116:119], v[64:67], v[76:79], v[116:119]
    s_waitcnt lgkmcnt(9)
    v_mfma_f32_16x16x32_bf16 v[120:123], v[68:71], v[76:79], v[120:123]
    s_waitcnt lgkmcnt(6)
    v_mfma_f32_16x16x32_bf16 v[124:127], v[72:75], v[76:79], v[124:127]
    v_mfma_f32_16x16x32_bf16 v[128:131], v[60:63], v[80:83], v[128:131]
    v_mfma_f32_16x16x32_bf16 v[132:135], v[64:67], v[80:83], v[132:135]
    v_mfma_f32_16x16x32_bf16 v[136:139], v[68:71], v[80:83], v[136:139]
    v_mfma_f32_16x16x32_bf16 v[140:143], v[72:75], v[80:83], v[140:143]
    s_waitcnt lgkmcnt(0)
    s_barrier
    ds_read_b128 v[76:79], v32 offset:18432
    ds_read_b128 v[80:83], v32 offset:20480
    v_mfma_f32_16x16x32_bf16 v[144:147], v[60:63], v[84:87], v[144:147]
    ds_read_b64_tr_b16 v[44:45], v28 offset:16384
    v_mfma_f32_16x16x32_bf16 v[148:151], v[64:67], v[84:87], v[148:151]
    v_mfma_f32_16x16x32_bf16 v[152:155], v[68:71], v[84:87], v[152:155]
    ds_read_b64_tr_b16 v[46:47], v28 offset:17408
    v_mfma_f32_16x16x32_bf16 v[156:159], v[72:75], v[84:87], v[156:159]
    ds_read_b128 v[84:87], v32 offset:22528
    v_mfma_f32_16x16x32_bf16 v[160:163], v[60:63], v[88:91], v[160:163]
    ds_read_b64_tr_b16 v[48:49], v29 offset:16384
    v_mfma_f32_16x16x32_bf16 v[164:167], v[64:67], v[88:91], v[164:167]
    v_mfma_f32_16x16x32_bf16 v[168:171], v[68:71], v[88:91], v[168:171]
    ds_read_b64_tr_b16 v[50:51], v29 offset:17408
    v_mfma_f32_16x16x32_bf16 v[172:175], v[72:75], v[88:91], v[172:175]
    ds_read_b128 v[88:91], v32 offset:24576
    v_mfma_f32_16x16x32_bf16 v[176:179], v[60:63], v[92:95], v[176:179]
    ds_read_b64_tr_b16 v[52:53], v30 offset:16384
    v_mfma_f32_16x16x32_bf16 v[180:183], v[64:67], v[92:95], v[180:183]
    v_mfma_f32_16x16x32_bf16 v[184:187], v[68:71], v[92:95], v[184:187]
    ds_read_b64_tr_b16 v[54:55], v30 offset:17408
    v_mfma_f32_16x16x32_bf16 v[188:191], v[72:75], v[92:95], v[188:191]
    ds_read_b128 v[92:95], v32 offset:26624
    v_mfma_f32_16x16x32_bf16 v[192:195], v[60:63], v[96:99], v[192:195]
    ds_read_b64_tr_b16 v[56:57], v31 offset:16384
    v_mfma_f32_16x16x32_bf16 v[196:199], v[64:67], v[96:99], v[196:199]
    v_mfma_f32_16x16x32_bf16 v[200:203], v[68:71], v[96:99], v[200:203]
    ds_read_b64_tr_b16 v[58:59], v31 offset:17408
    v_mfma_f32_16x16x32_bf16 v[204:207], v[72:75], v[96:99], v[204:207]
    ds_read_b128 v[96:99], v32 offset:28672
    v_mfma_f32_16x16x32_bf16 v[208:211], v[60:63], v[100:103], v[208:211]
    v_mfma_f32_16x16x32_bf16 v[212:215], v[64:67], v[100:103], v[212:215]
    v_mfma_f32_16x16x32_bf16 v[216:219], v[68:71], v[100:103], v[216:219]
    v_mfma_f32_16x16x32_bf16 v[220:223], v[72:75], v[100:103], v[220:223]
    ds_read_b128 v[100:103], v32 offset:30720
    v_mfma_f32_16x16x32_bf16 v[224:227], v[60:63], v[104:107], v[224:227]
    v_mfma_f32_16x16x32_bf16 v[228:231], v[64:67], v[104:107], v[228:231]
    v_mfma_f32_16x16x32_bf16 v[232:235], v[68:71], v[104:107], v[232:235]
    v_mfma_f32_16x16x32_bf16 v[236:239], v[72:75], v[104:107], v[236:239]
    ds_read_b128 v[104:107], v32 offset:32768
    v_mfma_f32_16x16x32_bf16 v[240:243], v[60:63], v[108:111], v[240:243]
    v_mfma_f32_16x16x32_bf16 v[244:247], v[64:67], v[108:111], v[244:247]
    v_mfma_f32_16x16x32_bf16 v[248:251], v[68:71], v[108:111], v[248:251]
    v_mfma_f32_16x16x32_bf16 v[252:255], v[72:75], v[108:111], v[252:255]
    ds_read_b128 v[108:111], v32 offset:34816
    s_waitcnt lgkmcnt(13)
    v_mfma_f32_16x16x32_bf16 v[112:115], v[44:47], v[76:79], v[112:115]
    ds_read_b64_tr_b16 v[60:61], v28 offset:18432
    s_waitcnt lgkmcnt(11)
    v_mfma_f32_16x16x32_bf16 v[116:119], v[48:51], v[76:79], v[116:119]
    s_waitcnt lgkmcnt(8)
    v_mfma_f32_16x16x32_bf16 v[120:123], v[52:55], v[76:79], v[120:123]
    ds_read_b64_tr_b16 v[62:63], v28 offset:19456
    s_waitcnt lgkmcnt(6)
    v_mfma_f32_16x16x32_bf16 v[124:127], v[56:59], v[76:79], v[124:127]
    ds_read_b128 v[76:79], v33 offset:18432
    v_mfma_f32_16x16x32_bf16 v[128:131], v[44:47], v[80:83], v[128:131]
    ds_read_b64_tr_b16 v[64:65], v29 offset:18432
    v_mfma_f32_16x16x32_bf16 v[132:135], v[48:51], v[80:83], v[132:135]
    v_mfma_f32_16x16x32_bf16 v[136:139], v[52:55], v[80:83], v[136:139]
    ds_read_b64_tr_b16 v[66:67], v29 offset:19456
    v_mfma_f32_16x16x32_bf16 v[140:143], v[56:59], v[80:83], v[140:143]
    ds_read_b128 v[80:83], v33 offset:20480
    v_mfma_f32_16x16x32_bf16 v[144:147], v[44:47], v[84:87], v[144:147]
    ds_read_b64_tr_b16 v[68:69], v30 offset:18432
    v_mfma_f32_16x16x32_bf16 v[148:151], v[48:51], v[84:87], v[148:151]
    v_mfma_f32_16x16x32_bf16 v[152:155], v[52:55], v[84:87], v[152:155]
    ds_read_b64_tr_b16 v[70:71], v30 offset:19456
    v_mfma_f32_16x16x32_bf16 v[156:159], v[56:59], v[84:87], v[156:159]
    ds_read_b128 v[84:87], v33 offset:22528
    v_mfma_f32_16x16x32_bf16 v[160:163], v[44:47], v[88:91], v[160:163]
    ds_read_b64_tr_b16 v[72:73], v31 offset:18432
    v_mfma_f32_16x16x32_bf16 v[164:167], v[48:51], v[88:91], v[164:167]
    v_mfma_f32_16x16x32_bf16 v[168:171], v[52:55], v[88:91], v[168:171]
    ds_read_b64_tr_b16 v[74:75], v31 offset:19456
    v_mfma_f32_16x16x32_bf16 v[172:175], v[56:59], v[88:91], v[172:175]
    ds_read_b128 v[88:91], v33 offset:24576
    v_mfma_f32_16x16x32_bf16 v[176:179], v[44:47], v[92:95], v[176:179]
    v_mfma_f32_16x16x32_bf16 v[180:183], v[48:51], v[92:95], v[180:183]
    v_mfma_f32_16x16x32_bf16 v[184:187], v[52:55], v[92:95], v[184:187]
    v_mfma_f32_16x16x32_bf16 v[188:191], v[56:59], v[92:95], v[188:191]
    ds_read_b128 v[92:95], v33 offset:26624
    s_waitcnt lgkmcnt(15)
    v_mfma_f32_16x16x32_bf16 v[192:195], v[44:47], v[96:99], v[192:195]
    v_mfma_f32_16x16x32_bf16 v[196:199], v[48:51], v[96:99], v[196:199]
    v_mfma_f32_16x16x32_bf16 v[200:203], v[52:55], v[96:99], v[200:203]
    v_mfma_f32_16x16x32_bf16 v[204:207], v[56:59], v[96:99], v[204:207]
    ds_read_b128 v[96:99], v33 offset:28672
    v_mfma_f32_16x16x32_bf16 v[208:211], v[44:47], v[100:103], v[208:211]
    v_mfma_f32_16x16x32_bf16 v[212:215], v[48:51], v[100:103], v[212:215]
    v_mfma_f32_16x16x32_bf16 v[216:219], v[52:55], v[100:103], v[216:219]
    v_mfma_f32_16x16x32_bf16 v[220:223], v[56:59], v[100:103], v[220:223]
    ds_read_b128 v[100:103], v33 offset:30720
    s_waitcnt lgkmcnt(15)
    v_mfma_f32_16x16x32_bf16 v[224:227], v[44:47], v[104:107], v[224:227]
    v_mfma_f32_16x16x32_bf16 v[228:231], v[48:51], v[104:107], v[228:231]
    v_mfma_f32_16x16x32_bf16 v[232:235], v[52:55], v[104:107], v[232:235]
    v_mfma_f32_16x16x32_bf16 v[236:239], v[56:59], v[104:107], v[236:239]
    ds_read_b128 v[104:107], v33 offset:32768
    v_mfma_f32_16x16x32_bf16 v[240:243], v[44:47], v[108:111], v[240:243]
    v_mfma_f32_16x16x32_bf16 v[244:247], v[48:51], v[108:111], v[244:247]
    v_mfma_f32_16x16x32_bf16 v[248:251], v[52:55], v[108:111], v[248:251]
    v_mfma_f32_16x16x32_bf16 v[252:255], v[56:59], v[108:111], v[252:255]
    ds_read_b128 v[108:111], v33 offset:34816
    s_waitcnt lgkmcnt(14)
    v_mfma_f32_16x16x32_bf16 v[112:115], v[60:63], v[76:79], v[112:115]
    s_waitcnt lgkmcnt(12)
    v_mfma_f32_16x16x32_bf16 v[116:119], v[64:67], v[76:79], v[116:119]
    s_waitcnt lgkmcnt(9)
    v_mfma_f32_16x16x32_bf16 v[120:123], v[68:71], v[76:79], v[120:123]
    s_waitcnt lgkmcnt(6)
    v_mfma_f32_16x16x32_bf16 v[124:127], v[72:75], v[76:79], v[124:127]
    v_mfma_f32_16x16x32_bf16 v[128:131], v[60:63], v[80:83], v[128:131]
    v_mfma_f32_16x16x32_bf16 v[132:135], v[64:67], v[80:83], v[132:135]
    v_mfma_f32_16x16x32_bf16 v[136:139], v[68:71], v[80:83], v[136:139]
    v_mfma_f32_16x16x32_bf16 v[140:143], v[72:75], v[80:83], v[140:143]
    s_waitcnt lgkmcnt(0)
    s_barrier
    ds_read_b128 v[76:79], v32 offset:36864
    ds_read_b128 v[80:83], v32 offset:38912
    v_mfma_f32_16x16x32_bf16 v[144:147], v[60:63], v[84:87], v[144:147]
    ds_read_b64_tr_b16 v[44:45], v28 offset:32768
    v_mfma_f32_16x16x32_bf16 v[148:151], v[64:67], v[84:87], v[148:151]
    v_mfma_f32_16x16x32_bf16 v[152:155], v[68:71], v[84:87], v[152:155]
    ds_read_b64_tr_b16 v[46:47], v28 offset:33792
    v_mfma_f32_16x16x32_bf16 v[156:159], v[72:75], v[84:87], v[156:159]
    ds_read_b128 v[84:87], v32 offset:40960
    v_mfma_f32_16x16x32_bf16 v[160:163], v[60:63], v[88:91], v[160:163]
    ds_read_b64_tr_b16 v[48:49], v29 offset:32768
    v_mfma_f32_16x16x32_bf16 v[164:167], v[64:67], v[88:91], v[164:167]
    v_mfma_f32_16x16x32_bf16 v[168:171], v[68:71], v[88:91], v[168:171]
    ds_read_b64_tr_b16 v[50:51], v29 offset:33792
    v_mfma_f32_16x16x32_bf16 v[172:175], v[72:75], v[88:91], v[172:175]
    ds_read_b128 v[88:91], v32 offset:43008
    v_mfma_f32_16x16x32_bf16 v[176:179], v[60:63], v[92:95], v[176:179]
    ds_read_b64_tr_b16 v[52:53], v30 offset:32768
    v_mfma_f32_16x16x32_bf16 v[180:183], v[64:67], v[92:95], v[180:183]
    v_mfma_f32_16x16x32_bf16 v[184:187], v[68:71], v[92:95], v[184:187]
    ds_read_b64_tr_b16 v[54:55], v30 offset:33792
    v_mfma_f32_16x16x32_bf16 v[188:191], v[72:75], v[92:95], v[188:191]
    ds_read_b128 v[92:95], v32 offset:45056
    v_mfma_f32_16x16x32_bf16 v[192:195], v[60:63], v[96:99], v[192:195]
    ds_read_b64_tr_b16 v[56:57], v31 offset:32768
    v_mfma_f32_16x16x32_bf16 v[196:199], v[64:67], v[96:99], v[196:199]
    v_mfma_f32_16x16x32_bf16 v[200:203], v[68:71], v[96:99], v[200:203]
    ds_read_b64_tr_b16 v[58:59], v31 offset:33792
    v_mfma_f32_16x16x32_bf16 v[204:207], v[72:75], v[96:99], v[204:207]
    ds_read_b128 v[96:99], v32 offset:47104
    v_mfma_f32_16x16x32_bf16 v[208:211], v[60:63], v[100:103], v[208:211]
    v_mfma_f32_16x16x32_bf16 v[212:215], v[64:67], v[100:103], v[212:215]
    v_mfma_f32_16x16x32_bf16 v[216:219], v[68:71], v[100:103], v[216:219]
    v_mfma_f32_16x16x32_bf16 v[220:223], v[72:75], v[100:103], v[220:223]
    ds_read_b128 v[100:103], v32 offset:49152
    v_mfma_f32_16x16x32_bf16 v[224:227], v[60:63], v[104:107], v[224:227]
    v_mfma_f32_16x16x32_bf16 v[228:231], v[64:67], v[104:107], v[228:231]
    v_mfma_f32_16x16x32_bf16 v[232:235], v[68:71], v[104:107], v[232:235]
    v_mfma_f32_16x16x32_bf16 v[236:239], v[72:75], v[104:107], v[236:239]
    ds_read_b128 v[104:107], v32 offset:51200
    v_mfma_f32_16x16x32_bf16 v[240:243], v[60:63], v[108:111], v[240:243]
    v_mfma_f32_16x16x32_bf16 v[244:247], v[64:67], v[108:111], v[244:247]
    v_mfma_f32_16x16x32_bf16 v[248:251], v[68:71], v[108:111], v[248:251]
    v_mfma_f32_16x16x32_bf16 v[252:255], v[72:75], v[108:111], v[252:255]
    ds_read_b128 v[108:111], v32 offset:53248
    s_waitcnt lgkmcnt(13)
    v_mfma_f32_16x16x32_bf16 v[112:115], v[44:47], v[76:79], v[112:115]
    ds_read_b64_tr_b16 v[60:61], v28 offset:34816
    s_waitcnt lgkmcnt(11)
    v_mfma_f32_16x16x32_bf16 v[116:119], v[48:51], v[76:79], v[116:119]
    s_waitcnt lgkmcnt(8)
    v_mfma_f32_16x16x32_bf16 v[120:123], v[52:55], v[76:79], v[120:123]
    ds_read_b64_tr_b16 v[62:63], v28 offset:35840
    s_waitcnt lgkmcnt(6)
    v_mfma_f32_16x16x32_bf16 v[124:127], v[56:59], v[76:79], v[124:127]
    ds_read_b128 v[76:79], v33 offset:36864
    v_mfma_f32_16x16x32_bf16 v[128:131], v[44:47], v[80:83], v[128:131]
    ds_read_b64_tr_b16 v[64:65], v29 offset:34816
    v_mfma_f32_16x16x32_bf16 v[132:135], v[48:51], v[80:83], v[132:135]
    v_mfma_f32_16x16x32_bf16 v[136:139], v[52:55], v[80:83], v[136:139]
    ds_read_b64_tr_b16 v[66:67], v29 offset:35840
    v_mfma_f32_16x16x32_bf16 v[140:143], v[56:59], v[80:83], v[140:143]
    ds_read_b128 v[80:83], v33 offset:38912
    v_mfma_f32_16x16x32_bf16 v[144:147], v[44:47], v[84:87], v[144:147]
    ds_read_b64_tr_b16 v[68:69], v30 offset:34816
    v_mfma_f32_16x16x32_bf16 v[148:151], v[48:51], v[84:87], v[148:151]
    v_mfma_f32_16x16x32_bf16 v[152:155], v[52:55], v[84:87], v[152:155]
    ds_read_b64_tr_b16 v[70:71], v30 offset:35840
    v_mfma_f32_16x16x32_bf16 v[156:159], v[56:59], v[84:87], v[156:159]
    ds_read_b128 v[84:87], v33 offset:40960
    v_mfma_f32_16x16x32_bf16 v[160:163], v[44:47], v[88:91], v[160:163]
    ds_read_b64_tr_b16 v[72:73], v31 offset:34816
    v_mfma_f32_16x16x32_bf16 v[164:167], v[48:51], v[88:91], v[164:167]
    v_mfma_f32_16x16x32_bf16 v[168:171], v[52:55], v[88:91], v[168:171]
    ds_read_b64_tr_b16 v[74:75], v31 offset:35840
    v_mfma_f32_16x16x32_bf16 v[172:175], v[56:59], v[88:91], v[172:175]
    ds_read_b128 v[88:91], v33 offset:43008
    v_mfma_f32_16x16x32_bf16 v[176:179], v[44:47], v[92:95], v[176:179]
    v_mfma_f32_16x16x32_bf16 v[180:183], v[48:51], v[92:95], v[180:183]
    v_mfma_f32_16x16x32_bf16 v[184:187], v[52:55], v[92:95], v[184:187]
    v_mfma_f32_16x16x32_bf16 v[188:191], v[56:59], v[92:95], v[188:191]
    ds_read_b128 v[92:95], v33 offset:45056
    s_waitcnt lgkmcnt(15)
    v_mfma_f32_16x16x32_bf16 v[192:195], v[44:47], v[96:99], v[192:195]
    v_mfma_f32_16x16x32_bf16 v[196:199], v[48:51], v[96:99], v[196:199]
    v_mfma_f32_16x16x32_bf16 v[200:203], v[52:55], v[96:99], v[200:203]
    v_mfma_f32_16x16x32_bf16 v[204:207], v[56:59], v[96:99], v[204:207]
    ds_read_b128 v[96:99], v33 offset:47104
    v_mfma_f32_16x16x32_bf16 v[208:211], v[44:47], v[100:103], v[208:211]
    v_mfma_f32_16x16x32_bf16 v[212:215], v[48:51], v[100:103], v[212:215]
    v_mfma_f32_16x16x32_bf16 v[216:219], v[52:55], v[100:103], v[216:219]
    v_mfma_f32_16x16x32_bf16 v[220:223], v[56:59], v[100:103], v[220:223]
    ds_read_b128 v[100:103], v33 offset:49152
    s_waitcnt lgkmcnt(15)
    v_mfma_f32_16x16x32_bf16 v[224:227], v[44:47], v[104:107], v[224:227]
    v_mfma_f32_16x16x32_bf16 v[228:231], v[48:51], v[104:107], v[228:231]
    v_mfma_f32_16x16x32_bf16 v[232:235], v[52:55], v[104:107], v[232:235]
    v_mfma_f32_16x16x32_bf16 v[236:239], v[56:59], v[104:107], v[236:239]
    ds_read_b128 v[104:107], v33 offset:51200
    v_mfma_f32_16x16x32_bf16 v[240:243], v[44:47], v[108:111], v[240:243]
    v_mfma_f32_16x16x32_bf16 v[244:247], v[48:51], v[108:111], v[244:247]
    v_mfma_f32_16x16x32_bf16 v[248:251], v[52:55], v[108:111], v[248:251]
    v_mfma_f32_16x16x32_bf16 v[252:255], v[56:59], v[108:111], v[252:255]
    ds_read_b128 v[108:111], v33 offset:53248
    s_waitcnt lgkmcnt(14)
    v_mfma_f32_16x16x32_bf16 v[112:115], v[60:63], v[76:79], v[112:115]
    s_waitcnt lgkmcnt(12)
    v_mfma_f32_16x16x32_bf16 v[116:119], v[64:67], v[76:79], v[116:119]
    s_waitcnt lgkmcnt(9)
    v_mfma_f32_16x16x32_bf16 v[120:123], v[68:71], v[76:79], v[120:123]
    s_waitcnt lgkmcnt(6)
    v_mfma_f32_16x16x32_bf16 v[124:127], v[72:75], v[76:79], v[124:127]
    v_mfma_f32_16x16x32_bf16 v[128:131], v[60:63], v[80:83], v[128:131]
    v_mfma_f32_16x16x32_bf16 v[132:135], v[64:67], v[80:83], v[132:135]
    v_mfma_f32_16x16x32_bf16 v[136:139], v[68:71], v[80:83], v[136:139]
    v_mfma_f32_16x16x32_bf16 v[140:143], v[72:75], v[80:83], v[140:143]
    s_waitcnt lgkmcnt(0)
    s_barrier
    ds_read_b128 v[76:79], v32 offset:0
    ds_read_b128 v[80:83], v32 offset:2048
    v_mfma_f32_16x16x32_bf16 v[144:147], v[60:63], v[84:87], v[144:147]
    ds_read_b64_tr_b16 v[44:45], v28 offset:0
    v_mfma_f32_16x16x32_bf16 v[148:151], v[64:67], v[84:87], v[148:151]
    v_mfma_f32_16x16x32_bf16 v[152:155], v[68:71], v[84:87], v[152:155]
    ds_read_b64_tr_b16 v[46:47], v28 offset:1024
    v_mfma_f32_16x16x32_bf16 v[156:159], v[72:75], v[84:87], v[156:159]
    ds_read_b128 v[84:87], v32 offset:4096
    v_mfma_f32_16x16x32_bf16 v[160:163], v[60:63], v[88:91], v[160:163]
    ds_read_b64_tr_b16 v[48:49], v29 offset:0
    v_mfma_f32_16x16x32_bf16 v[164:167], v[64:67], v[88:91], v[164:167]
    v_mfma_f32_16x16x32_bf16 v[168:171], v[68:71], v[88:91], v[168:171]
    ds_read_b64_tr_b16 v[50:51], v29 offset:1024
    v_mfma_f32_16x16x32_bf16 v[172:175], v[72:75], v[88:91], v[172:175]
    ds_read_b128 v[88:91], v32 offset:6144
    v_mfma_f32_16x16x32_bf16 v[176:179], v[60:63], v[92:95], v[176:179]
    ds_read_b64_tr_b16 v[52:53], v30 offset:0
    v_mfma_f32_16x16x32_bf16 v[180:183], v[64:67], v[92:95], v[180:183]
    v_mfma_f32_16x16x32_bf16 v[184:187], v[68:71], v[92:95], v[184:187]
    ds_read_b64_tr_b16 v[54:55], v30 offset:1024
    v_mfma_f32_16x16x32_bf16 v[188:191], v[72:75], v[92:95], v[188:191]
    ds_read_b128 v[92:95], v32 offset:8192
    v_mfma_f32_16x16x32_bf16 v[192:195], v[60:63], v[96:99], v[192:195]
    ds_read_b64_tr_b16 v[56:57], v31 offset:0
    v_mfma_f32_16x16x32_bf16 v[196:199], v[64:67], v[96:99], v[196:199]
    v_mfma_f32_16x16x32_bf16 v[200:203], v[68:71], v[96:99], v[200:203]
    ds_read_b64_tr_b16 v[58:59], v31 offset:1024
    v_mfma_f32_16x16x32_bf16 v[204:207], v[72:75], v[96:99], v[204:207]
    ds_read_b128 v[96:99], v32 offset:10240
    v_mfma_f32_16x16x32_bf16 v[208:211], v[60:63], v[100:103], v[208:211]
    v_mfma_f32_16x16x32_bf16 v[212:215], v[64:67], v[100:103], v[212:215]
    v_mfma_f32_16x16x32_bf16 v[216:219], v[68:71], v[100:103], v[216:219]
    v_mfma_f32_16x16x32_bf16 v[220:223], v[72:75], v[100:103], v[220:223]
    ds_read_b128 v[100:103], v32 offset:12288
    v_mfma_f32_16x16x32_bf16 v[224:227], v[60:63], v[104:107], v[224:227]
    v_mfma_f32_16x16x32_bf16 v[228:231], v[64:67], v[104:107], v[228:231]
    v_mfma_f32_16x16x32_bf16 v[232:235], v[68:71], v[104:107], v[232:235]
    v_mfma_f32_16x16x32_bf16 v[236:239], v[72:75], v[104:107], v[236:239]
    ds_read_b128 v[104:107], v32 offset:14336
    v_mfma_f32_16x16x32_bf16 v[240:243], v[60:63], v[108:111], v[240:243]
    v_mfma_f32_16x16x32_bf16 v[244:247], v[64:67], v[108:111], v[244:247]
    v_mfma_f32_16x16x32_bf16 v[248:251], v[68:71], v[108:111], v[248:251]
    v_mfma_f32_16x16x32_bf16 v[252:255], v[72:75], v[108:111], v[252:255]
    ds_read_b128 v[108:111], v32 offset:16384
    s_add_u32 s55, s55, 1
    s_cmp_lt_u32 s55, 5
    s_cbranch_scc1 k1_qloop
    s_waitcnt lgkmcnt(13)
    v_mfma_f32_16x16x32_bf16 v[112:115], v[44:47], v[76:79], v[112:115]
    ds_read_b64_tr_b16 v[60:61], v28 offset:2048
    s_waitcnt lgkmcnt(11)
    v_mfma_f32_16x16x32_bf16 v[116:119], v[48:51], v[76:79], v[116:119]
    s_waitcnt lgkmcnt(8)
    v_mfma_f32_16x16x32_bf16 v[120:123], v[52:55], v[76:79], v[120:123]
    ds_read_b64_tr_b16 v[62:63], v28 offset:3072
    s_waitcnt lgkmcnt(6)
    v_mfma_f32_16x16x32_bf16 v[124:127], v[56:59], v[76:79], v[124:127]
    ds_read_b128 v[76:79], v33 offset:0
    v_mfma_f32_16x16x32_bf16 v[128:131], v[44:47], v[80:83], v[128:131]
    ds_read_b64_tr_b16 v[64:65], v29 offset:2048
    v_mfma_f32_16x16x32_bf16 v[132:135], v[48:51], v[80:83], v[132:135]
    v_mfma_f32_16x16x32_bf16 v[136:139], v[52:55], v[80:83], v[136:139]
    ds_read_b64_tr_b16 v[66:67], v29 offset:3072
    v_mfma_f32_16x16x32_bf16 v[140:143], v[56:59], v[80:83], v[140:143]
    ds_read_b128 v[80:83], v33 offset:2048
    v_mfma_f32_16x16x32_bf16 v[144:147], v[44:47], v[84:87], v[144:147]
    ds_read_b64_tr_b16 v[68:69], v30 offset:2048
    v_mfma_f32_16x16x32_bf16 v[148:151], v[48:51], v[84:87], v[148:151]
    v_mfma_f32_16x16x32_bf16 v[152:155], v[52:55], v[84:87], v[152:155]
    ds_read_b64_tr_b16 v[70:71], v30 offset:3072
    v_mfma_f32_16x16x32_bf16 v[156:159], v[56:59], v[84:87], v[156:159]
    ds_read_b128 v[84:87], v33 offset:4096
    v_mfma_f32_16x16x32_bf16 v[160:163], v[44:47], v[88:91], v[160:163]
    ds_read_b64_tr_b16 v[72:73], v31 offset:2048
    v_mfma_f32_16x16x32_bf16 v[164:167], v[48:51], v[88:91], v[164:167]
    v_mfma_f32_16x16x32_bf16 v[168:171], v[52:55], v[88:91], v[168:171]
    ds_read_b64_tr_b16 v[74:75], v31 offset:3072
    v_mfma_f32_16x16x32_bf16 v[172:175], v[56:59], v[88:91], v[172:175]
    ds_read_b128 v[88:91], v33 offset:6144
    v_mfma_f32_16x16x32_bf16 v[176:179], v[44:47], v[92:95], v[176:179]
    v_mfma_f32_16x16x32_bf16 v[180:183], v[48:51], v[92:95], v[180:183]
    v_mfma_f32_16x16x32_bf16 v[184:187], v[52:55], v[92:95], v[184:187]
    v_mfma_f32_16x16x32_bf16 v[188:191], v[56:59], v[92:95], v[188:191]
    ds_read_b128 v[92:95], v33 offset:8192
    s_waitcnt lgkmcnt(15)
    v_mfma_f32_16x16x32_bf16 v[192:195], v[44:47], v[96:99], v[192:195]
    v_mfma_f32_16x16x32_bf16 v[196:199], v[48:51], v[96:99], v[196:199]
    v_mfma_f32_16x16x32_bf16 v[200:203], v[52:55], v[96:99], v[200:203]
    v_mfma_f32_16x16x32_bf16 v[204:207], v[56:59], v[96:99], v[204:207]
    ds_read_b128 v[96:99], v33 offset:10240
    v_mfma_f32_16x16x32_bf16 v[208:211], v[44:47], v[100:103], v[208:211]
    v_mfma_f32_16x16x32_bf16 v[212:215], v[48:51], v[100:103], v[212:215]
    v_mfma_f32_16x16x32_bf16 v[216:219], v[52:55], v[100:103], v[216:219]
    v_mfma_f32_16x16x32_bf16 v[220:223], v[56:59], v[100:103], v[220:223]
    ds_read_b128 v[100:103], v33 offset:12288
    s_waitcnt lgkmcnt(15)
    v_mfma_f32_16x16x32_bf16 v[224:227], v[44:47], v[104:107], v[224:227]
    v_mfma_f32_16x16x32_bf16 v[228:231], v[48:51], v[104:107], v[228:231]
    v_mfma_f32_16x16x32_bf16 v[232:235], v[52:55], v[104:107], v[232:235]
    v_mfma_f32_16x16x32_bf16 v[236:239], v[56:59], v[104:107], v[236:239]
    ds_read_b128 v[104:107], v33 offset:14336
    v_mfma_f32_16x16x32_bf16 v[240:243], v[44:47], v[108:111], v[240:243]
    v_mfma_f32_16x16x32_bf16 v[244:247], v[48:51], v[108:111], v[244:247]
    v_mfma_f32_16x16x32_bf16 v[248:251], v[52:55], v[108:111], v[248:251]
    v_mfma_f32_16x16x32_bf16 v[252:255], v[56:59], v[108:111], v[252:255]
    ds_read_b128 v[108:111], v33 offset:16384
    s_waitcnt lgkmcnt(14)
    v_mfma_f32_16x16x32_bf16 v[112:115], v[60:63], v[76:79], v[112:115]
    s_waitcnt lgkmcnt(12)
    v_mfma_f32_16x16x32_bf16 v[116:119], v[64:67], v[76:79], v[116:119]
    s_waitcnt lgkmcnt(9)
    v_mfma_f32_16x16x32_bf16 v[120:123], v[68:71], v[76:79], v[120:123]
    s_waitcnt lgkmcnt(6)
    v_mfma_f32_16x16x32_bf16 v[124:127], v[72:75], v[76:79], v[124:127]
    v_mfma_f32_16x16x32_bf16 v[128:131], v[60:63], v[80:83], v[128:131]
    v_mfma_f32_16x16x32_bf16 v[132:135], v[64:67], v[80:83], v[132:135]
    v_mfma_f32_16x16x32_bf16 v[136:139], v[68:71], v[80:83], v[136:139]
    v_mfma_f32_16x16x32_bf16 v[140:143], v[72:75], v[80:83], v[140:143]
    s_waitcnt lgkmcnt(0)
    s_barrier
    v_mfma_f32_16x16x32_bf16 v[144:147], v[60:63], v[84:87], v[144:147]
    v_pk_mul_f32 v[112:113], v[112:113], s[70:71]
    v_pk_mul_f32 v[114:115], v[114:115], s[70:71]
    v_pk_mul_f32 v[116:117], v[116:117], s[70:71]
    v_pk_mul_f32 v[118:119], v[118:119], s[70:71]
    v_pk_mul_f32 v[120:121], v[120:121], s[70:71]
    v_pk_mul_f32 v[122:123], v[122:123], s[70:71]
    v_pk_mul_f32 v[124:125], v[124:125], s[70:71]
    v_mfma_f32_16x16x32_bf16 v[148:151], v[64:67], v[84:87], v[148:151]
    v_pk_mul_f32 v[126:127], v[126:127], s[70:71]
    v_cvt_pk_bf16_f32 v112, v112, v113
    v_cvt_pk_bf16_f32 v113, v114, v115
    v_cvt_pk_bf16_f32 v116, v116, v117
    v_cvt_pk_bf16_f32 v117, v118, v119
    v_cvt_pk_bf16_f32 v120, v120, v121
    v_cvt_pk_bf16_f32 v121, v122, v123
    v_mfma_f32_16x16x32_bf16 v[152:155], v[68:71], v[84:87], v[152:155]
    v_cvt_pk_bf16_f32 v124, v124, v125
    v_cvt_pk_bf16_f32 v125, v126, v127
    ds_write_b64 v34, v[112:113] offset:0
    ds_write_b64 v34, v[116:117] offset:512
    ds_write_b64 v34, v[120:121] offset:1024
    ds_write_b64 v34, v[124:125] offset:1536
    v_mfma_f32_16x16x32_bf16 v[156:159], v[72:75], v[84:87], v[156:159]
    v_mfma_f32_16x16x32_bf16 v[160:163], v[60:63], v[88:91], v[160:163]
    v_pk_mul_f32 v[128:129], v[128:129], s[70:71]
    v_pk_mul_f32 v[130:131], v[130:131], s[70:71]
    v_pk_mul_f32 v[132:133], v[132:133], s[70:71]
    v_pk_mul_f32 v[134:135], v[134:135], s[70:71]
    v_pk_mul_f32 v[136:137], v[136:137], s[70:71]
    v_pk_mul_f32 v[138:139], v[138:139], s[70:71]
    v_pk_mul_f32 v[140:141], v[140:141], s[70:71]
    v_mfma_f32_16x16x32_bf16 v[164:167], v[64:67], v[88:91], v[164:167]
    v_pk_mul_f32 v[142:143], v[142:143], s[70:71]
    v_cvt_pk_bf16_f32 v128, v128, v129
    v_cvt_pk_bf16_f32 v129, v130, v131
    v_cvt_pk_bf16_f32 v132, v132, v133
    v_cvt_pk_bf16_f32 v133, v134, v135
    v_cvt_pk_bf16_f32 v136, v136, v137
    v_cvt_pk_bf16_f32 v137, v138, v139
    v_mfma_f32_16x16x32_bf16 v[168:171], v[68:71], v[88:91], v[168:171]
    v_cvt_pk_bf16_f32 v140, v140, v141
    v_cvt_pk_bf16_f32 v141, v142, v143
    ds_write_b64 v34, v[128:129] offset:4096
    ds_write_b64 v34, v[132:133] offset:4608
    ds_write_b64 v34, v[136:137] offset:5120
    ds_write_b64 v34, v[140:141] offset:5632
    v_mfma_f32_16x16x32_bf16 v[172:175], v[72:75], v[88:91], v[172:175]
    v_mfma_f32_16x16x32_bf16 v[176:179], v[60:63], v[92:95], v[176:179]
    v_pk_mul_f32 v[144:145], v[144:145], s[70:71]
    v_pk_mul_f32 v[146:147], v[146:147], s[70:71]
    v_pk_mul_f32 v[148:149], v[148:149], s[70:71]
    v_pk_mul_f32 v[150:151], v[150:151], s[70:71]
    v_pk_mul_f32 v[152:153], v[152:153], s[70:71]
    v_pk_mul_f32 v[154:155], v[154:155], s[70:71]
    v_pk_mul_f32 v[156:157], v[156:157], s[70:71]
    v_mfma_f32_16x16x32_bf16 v[180:183], v[64:67], v[92:95], v[180:183]
    v_pk_mul_f32 v[158:159], v[158:159], s[70:71]
    v_cvt_pk_bf16_f32 v144, v144, v145
    v_cvt_pk_bf16_f32 v145, v146, v147
    v_cvt_pk_bf16_f32 v148, v148, v149
    v_cvt_pk_bf16_f32 v149, v150, v151
    v_cvt_pk_bf16_f32 v152, v152, v153
    v_cvt_pk_bf16_f32 v153, v154, v155
    v_mfma_f32_16x16x32_bf16 v[184:187], v[68:71], v[92:95], v[184:187]
    v_cvt_pk_bf16_f32 v156, v156, v157
    v_cvt_pk_bf16_f32 v157, v158, v159
    ds_write_b64 v34, v[144:145] offset:8192
    ds_write_b64 v34, v[148:149] offset:8704
    ds_write_b64 v34, v[152:153] offset:9216
    ds_write_b64 v34, v[156:157] offset:9728
    v_mov_b64 v[148:149], 0
    v_mfma_f32_16x16x32_bf16 v[188:191], v[72:75], v[92:95], v[188:191]
    v_mov_b64 v[150:151], 0
    v_mov_b64 v[152:153], 0
    v_mov_b64 v[154:155], 0
    v_mov_b64 v[156:157], 0
    v_mov_b64 v[158:159], 0
    v_mfma_f32_16x16x32_bf16 v[192:195], v[60:63], v[96:99], v[192:195]
    v_pk_mul_f32 v[160:161], v[160:161], s[70:71]
    v_pk_mul_f32 v[162:163], v[162:163], s[70:71]
    v_pk_mul_f32 v[164:165], v[164:165], s[70:71]
    v_pk_mul_f32 v[166:167], v[166:167], s[70:71]
    v_pk_mul_f32 v[168:169], v[168:169], s[70:71]
    v_pk_mul_f32 v[170:171], v[170:171], s[70:71]
    v_pk_mul_f32 v[172:173], v[172:173], s[70:71]
    v_mfma_f32_16x16x32_bf16 v[196:199], v[64:67], v[96:99], v[196:199]
    v_pk_mul_f32 v[174:175], v[174:175], s[70:71]
    v_cvt_pk_bf16_f32 v160, v160, v161
    v_cvt_pk_bf16_f32 v161, v162, v163
    v_cvt_pk_bf16_f32 v164, v164, v165
    v_cvt_pk_bf16_f32 v165, v166, v167
    v_cvt_pk_bf16_f32 v168, v168, v169
    v_cvt_pk_bf16_f32 v169, v170, v171
    v_mfma_f32_16x16x32_bf16 v[200:203], v[68:71], v[96:99], v[200:203]
    v_cvt_pk_bf16_f32 v172, v172, v173
    v_cvt_pk_bf16_f32 v173, v174, v175
    ds_write_b64 v34, v[160:161] offset:12288
    ds_write_b64 v34, v[164:165] offset:12800
    ds_write_b64 v34, v[168:169] offset:13312
    ds_write_b64 v34, v[172:173] offset:13824
    v_mov_b64 v[160:161], 0
    v_mfma_f32_16x16x32_bf16 v[204:207], v[72:75], v[96:99], v[204:207]
    v_mov_b64 v[162:163], 0
    v_mov_b64 v[164:165], 0
    v_mov_b64 v[166:167], 0
    v_mov_b64 v[168:169], 0
    v_mov_b64 v[170:171], 0
    v_mov_b64 v[172:173], 0
    v_mov_b64 v[174:175], 0
    v_mfma_f32_16x16x32_bf16 v[208:211], v[60:63], v[100:103], v[208:211]
    v_pk_mul_f32 v[176:177], v[176:177], s[70:71]
    v_pk_mul_f32 v[178:179], v[178:179], s[70:71]
    v_pk_mul_f32 v[180:181], v[180:181], s[70:71]
    v_pk_mul_f32 v[182:183], v[182:183], s[70:71]
    v_pk_mul_f32 v[184:185], v[184:185], s[70:71]
    v_pk_mul_f32 v[186:187], v[186:187], s[70:71]
    v_pk_mul_f32 v[188:189], v[188:189], s[70:71]
    v_mfma_f32_16x16x32_bf16 v[212:215], v[64:67], v[100:103], v[212:215]
    v_pk_mul_f32 v[190:191], v[190:191], s[70:71]
    v_cvt_pk_bf16_f32 v176, v176, v177
    v_cvt_pk_bf16_f32 v177, v178, v179
    v_cvt_pk_bf16_f32 v180, v180, v181
    v_cvt_pk_bf16_f32 v181, v182, v183
    v_cvt_pk_bf16_f32 v184, v184, v185
    v_cvt_pk_bf16_f32 v185, v186, v187
    v_mfma_f32_16x16x32_bf16 v[216:219], v[68:71], v[100:103], v[216:219]
    v_cvt_pk_bf16_f32 v188, v188, v189
    v_cvt_pk_bf16_f32 v189, v190, v191
    ds_write_b64 v34, v[176:177] offset:16384
    ds_write_b64 v34, v[180:181] offset:16896
    ds_write_b64 v34, v[184:185] offset:17408
    ds_write_b64 v34, v[188:189] offset:17920
    v_mov_b64 v[176:177], 0
    v_mfma_f32_16x16x32_bf16 v[220:223], v[72:75], v[100:103], v[220:223]
    v_mov_b64 v[178:179], 0
    v_mov_b64 v[180:181], 0
    v_mov_b64 v[182:183], 0
    v_mov_b64 v[184:185], 0
    v_mov_b64 v[186:187], 0
    v_mov_b64 v[188:189], 0
    v_mov_b64 v[190:191], 0
    v_mfma_f32_16x16x32_bf16 v[224:227], v[60:63], v[104:107], v[224:227]
    v_pk_mul_f32 v[192:193], v[192:193], s[70:71]
    v_pk_mul_f32 v[194:195], v[194:195], s[70:71]
    v_pk_mul_f32 v[196:197], v[196:197], s[70:71]
    v_pk_mul_f32 v[198:199], v[198:199], s[70:71]
    v_pk_mul_f32 v[200:201], v[200:201], s[70:71]
    v_pk_mul_f32 v[202:203], v[202:203], s[70:71]
    v_pk_mul_f32 v[204:205], v[204:205], s[70:71]
    v_mfma_f32_16x16x32_bf16 v[228:231], v[64:67], v[104:107], v[228:231]
    v_pk_mul_f32 v[206:207], v[206:207], s[70:71]
    v_cvt_pk_bf16_f32 v192, v192, v193
    v_cvt_pk_bf16_f32 v193, v194, v195
    v_cvt_pk_bf16_f32 v196, v196, v197
    v_cvt_pk_bf16_f32 v197, v198, v199
    v_cvt_pk_bf16_f32 v200, v200, v201
    v_cvt_pk_bf16_f32 v201, v202, v203
    v_mfma_f32_16x16x32_bf16 v[232:235], v[68:71], v[104:107], v[232:235]
    v_cvt_pk_bf16_f32 v204, v204, v205
    v_cvt_pk_bf16_f32 v205, v206, v207
    ds_write_b64 v34, v[192:193] offset:20480
    ds_write_b64 v34, v[196:197] offset:20992
    ds_write_b64 v34, v[200:201] offset:21504
    ds_write_b64 v34, v[204:205] offset:22016
    v_mov_b64 v[192:193], 0
    v_mfma_f32_16x16x32_bf16 v[236:239], v[72:75], v[104:107], v[236:239]
    v_mov_b64 v[194:195], 0
    v_mov_b64 v[196:197], 0
    v_mov_b64 v[198:199], 0
    v_mov_b64 v[200:201], 0
    v_mov_b64 v[202:203], 0
    v_mov_b64 v[204:205], 0
    v_mov_b64 v[206:207], 0
    v_mfma_f32_16x16x32_bf16 v[240:243], v[60:63], v[108:111], v[240:243]
    v_pk_mul_f32 v[208:209], v[208:209], s[70:71]
    v_pk_mul_f32 v[210:211], v[210:211], s[70:71]
    v_pk_mul_f32 v[212:213], v[212:213], s[70:71]
    v_pk_mul_f32 v[214:215], v[214:215], s[70:71]
    v_pk_mul_f32 v[216:217], v[216:217], s[70:71]
    v_pk_mul_f32 v[218:219], v[218:219], s[70:71]
    v_pk_mul_f32 v[220:221], v[220:221], s[70:71]
    v_mfma_f32_16x16x32_bf16 v[244:247], v[64:67], v[108:111], v[244:247]
    v_pk_mul_f32 v[222:223], v[222:223], s[70:71]
    v_cvt_pk_bf16_f32 v208, v208, v209
    v_cvt_pk_bf16_f32 v209, v210, v211
    v_cvt_pk_bf16_f32 v212, v212, v213
    v_cvt_pk_bf16_f32 v213, v214, v215
    v_cvt_pk_bf16_f32 v216, v216, v217
    v_cvt_pk_bf16_f32 v217, v218, v219
    v_mfma_f32_16x16x32_bf16 v[248:251], v[68:71], v[108:111], v[248:251]
    v_cvt_pk_bf16_f32 v220, v220, v221
    v_cvt_pk_bf16_f32 v221, v222, v223
    ds_write_b64 v34, v[208:209] offset:24576
    ds_write_b64 v34, v[212:213] offset:25088
    ds_write_b64 v34, v[216:217] offset:25600
    ds_write_b64 v34, v[220:221] offset:26112
    v_mov_b64 v[208:209], 0
    v_mfma_f32_16x16x32_bf16 v[252:255], v[72:75], v[108:111], v[252:255]
    v_mov_b64 v[210:211], 0
    v_mov_b64 v[212:213], 0
    v_mov_b64 v[214:215], 0
    v_mov_b64 v[216:217], 0
    v_mov_b64 v[218:219], 0
    v_mov_b64 v[220:221], 0
    v_mov_b64 v[222:223], 0
    v_pk_mul_f32 v[224:225], v[224:225], s[70:71]
    v_pk_mul_f32 v[226:227], v[226:227], s[70:71]
    v_pk_mul_f32 v[228:229], v[228:229], s[70:71]
    v_pk_mul_f32 v[230:231], v[230:231], s[70:71]
    v_pk_mul_f32 v[232:233], v[232:233], s[70:71]
    v_pk_mul_f32 v[234:235], v[234:235], s[70:71]
    v_pk_mul_f32 v[236:237], v[236:237], s[70:71]
    v_pk_mul_f32 v[238:239], v[238:239], s[70:71]
    v_cvt_pk_bf16_f32 v224, v224, v225
    v_cvt_pk_bf16_f32 v225, v226, v227
    v_cvt_pk_bf16_f32 v228, v228, v229
    v_cvt_pk_bf16_f32 v229, v230, v231
    v_cvt_pk_bf16_f32 v232, v232, v233
    v_cvt_pk_bf16_f32 v233, v234, v235
    v_cvt_pk_bf16_f32 v236, v236, v237
    v_cvt_pk_bf16_f32 v237, v238, v239
    ds_write_b64 v34, v[224:225] offset:28672
    ds_write_b64 v34, v[228:229] offset:29184
    ds_write_b64 v34, v[232:233] offset:29696
    ds_write_b64 v34, v[236:237] offset:30208
    v_mov_b64 v[224:225], 0
    v_mov_b64 v[226:227], 0
    v_mov_b64 v[228:229], 0
    v_mov_b64 v[230:231], 0
    v_mov_b64 v[232:233], 0
    v_mov_b64 v[234:235], 0
    v_mov_b64 v[236:237], 0
    v_mov_b64 v[238:239], 0
    v_pk_mul_f32 v[240:241], v[240:241], s[70:71]
    v_pk_mul_f32 v[242:243], v[242:243], s[70:71]
    v_pk_mul_f32 v[244:245], v[244:245], s[70:71]
    v_pk_mul_f32 v[246:247], v[246:247], s[70:71]
    v_pk_mul_f32 v[248:249], v[248:249], s[70:71]
    v_pk_mul_f32 v[250:251], v[250:251], s[70:71]
    v_pk_mul_f32 v[252:253], v[252:253], s[70:71]
    v_pk_mul_f32 v[254:255], v[254:255], s[70:71]
    v_cvt_pk_bf16_f32 v240, v240, v241
    v_cvt_pk_bf16_f32 v241, v242, v243
    v_cvt_pk_bf16_f32 v244, v244, v245
    v_cvt_pk_bf16_f32 v245, v246, v247
    v_cvt_pk_bf16_f32 v248, v248, v249
    v_cvt_pk_bf16_f32 v249, v250, v251
    v_cvt_pk_bf16_f32 v252, v252, v253
    v_cvt_pk_bf16_f32 v253, v254, v255
    ds_write_b64 v34, v[240:241] offset:32768
    ds_write_b64 v34, v[244:245] offset:33280
    ds_write_b64 v34, v[248:249] offset:33792
    ds_write_b64 v34, v[252:253] offset:34304
    v_mov_b64 v[240:241], 0
    v_mov_b64 v[242:243], 0
    v_mov_b64 v[244:245], 0
    v_mov_b64 v[246:247], 0
    v_mov_b64 v[248:249], 0
    v_mov_b64 v[250:251], 0
    v_mov_b64 v[252:253], 0
    v_mov_b64 v[254:255], 0
    s_setprio 0
k1_join:
    s_mov_b32 s55, 0
    s_lshl_b32 s5, s42, 15
    s_add_u32 s5, s5, s60
    s_waitcnt lgkmcnt(0)
    s_barrier
    ds_read_b128 v[28:31], v9 offset:0
    ds_read_b128 v[32:35], v9 offset:1024
    ds_read_b128 v[36:39], v9 offset:2048
    ds_read_b128 v[40:43], v9 offset:3072
    ds_read_b128 v[44:47], v9 offset:4096
    ds_read_b128 v[48:51], v9 offset:5120
    ds_read_b128 v[52:55], v9 offset:6144
    ds_read_b128 v[56:59], v9 offset:7168
    ds_read_b128 v[60:63], v11 offset:32768
    ds_read_b128 v[64:67], v11 offset:33792
    ds_read_b128 v[68:71], v11 offset:34816
    ds_read_b128 v[72:75], v11 offset:35840
    s_waitcnt lgkmcnt(0)
    s_barrier
    s_mov_b32 m0, s5
    s_nop 0
    buffer_load_dwordx4 v7, s[28:31], s65 offen offset:0 nt lds
    buffer_load_dwordx4 v7, s[28:31], s65 offen offset:1024 nt lds
    buffer_load_dwordx4 v7, s[28:31], s65 offen offset:2048 nt lds
    buffer_load_dwordx4 v7, s[28:31], s65 offen offset:3072 nt lds
    s_add_u32 s65, s65, 16384
    s_cmp_eq_u32 s42, 0
    s_cbranch_scc1 k1_nowr
    ds_write_b128 v10, v[76:79] offset:32768
    ds_write_b128 v10, v[80:83] offset:33792
    ds_write_b128 v10, v[84:87] offset:34816
    ds_write_b128 v10, v[88:91] offset:35840
    ds_write_b128 v8, v[92:95] offset:0
    ds_write_b128 v8, v[96:99] offset:1024
    ds_write_b128 v8, v[100:103] offset:2048
    ds_write_b128 v8, v[104:107] offset:3072
    ds_write_b128 v10, v[108:111] offset:49152
    ds_write_b128 v10, v[112:115] offset:50176
    ds_write_b128 v10, v[116:119] offset:51200
    ds_write_b128 v10, v[120:123] offset:52224
    ds_write_b128 v8, v[124:127] offset:16384
    ds_write_b128 v8, v[128:131] offset:17408
    ds_write_b128 v8, v[132:135] offset:18432
    ds_write_b128 v8, v[136:139] offset:19456
k1_nowr:
    ds_read_b128 v[116:119], v1 offset:0
    ds_read_b128 v[120:123], v2 offset:0
    ds_read_b128 v[124:127], v1 offset:512
    ds_read_b128 v[128:131], v2 offset:512
    ds_read_b128 v[132:135], v1 offset:1024
    ds_read_b128 v[136:139], v2 offset:1024
    s_lshr_b32 s3, s41, 1
    s_xor_b32 s3, s3, s42
    s_cmp_eq_u32 s3, 1
    s_cbranch_scc1 k1_proL
    s_waitcnt lgkmcnt(5)
    v_mfma_f32_16x16x32_bf16 v[76:79], v[116:119], v[28:31], v[16:19]
    ds_read_b128 v[140:143], v1 offset:1536
    s_mov_b32 s72, s58
    s_cmp_ge_u32 s58, 49152
    s_cselect_b32 s62, 0xffff4000, s57
    s_add_u32 s58, s58, s62
    s_sub_u32 s62, s62, s47
    v_mfma_f32_16x16x32_bf16 v[92:95], v[116:119], v[44:47], v[20:23]
    v_mfma_f32_16x16x32_bf16 v[108:111], v[116:119], v[60:63], v[24:27]
    s_waitcnt lgkmcnt(5)
    v_mfma_f32_16x16x32_bf16 v[76:79], v[120:123], v[32:35], v[76:79]
    v_add_u32 v1, s47, v1
    ds_read_b128 v[144:147], v2 offset:1536
    v_mfma_f32_16x16x32_bf16 v[92:95], v[120:123], v[48:51], v[92:95]
    v_mfma_f32_16x16x32_bf16 v[108:111], v[120:123], v[64:67], v[108:111]
    s_waitcnt lgkmcnt(5)
    v_mfma_f32_16x16x32_bf16 v[76:79], v[124:127], v[36:39], v[76:79]
    v_add_u32 v2, s47, v2
    ds_read_b128 v[116:119], v1 offset:0
    v_mfma_f32_16x16x32_bf16 v[92:95], v[124:127], v[52:55], v[92:95]
    v_mfma_f32_16x16x32_bf16 v[108:111], v[124:127], v[68:71], v[108:111]
    s_waitcnt lgkmcnt(5)
    v_mfma_f32_16x16x32_bf16 v[76:79], v[128:131], v[40:43], v[76:79]
    ds_read_b128 v[120:123], v2 offset:0
    v_mfma_f32_16x16x32_bf16 v[92:95], v[128:131], v[56:59], v[92:95]
    v_mfma_f32_16x16x32_bf16 v[108:111], v[128:131], v[72:75], v[108:111]
    s_waitcnt lgkmcnt(5)
    v_mfma_f32_16x16x32_bf16 v[80:83], v[132:135], v[28:31], v[16:19]
    ds_read_b128 v[124:127], v1 offset:512
    v_mfma_f32_16x16x32_bf16 v[96:99], v[132:135], v[44:47], v[20:23]
    v_mfma_f32_16x16x32_bf16 v[112:115], v[132:135], v[60:63], v[24:27]
    s_waitcnt lgkmcnt(5)
    v_mfma_f32_16x16x32_bf16 v[80:83], v[136:139], v[32:35], v[80:83]
    ds_read_b128 v[128:131], v2 offset:512
    v_mfma_f32_16x16x32_bf16 v[96:99], v[136:139], v[48:51], v[96:99]
    v_mfma_f32_16x16x32_bf16 v[112:115], v[136:139], v[64:67], v[112:115]
    s_waitcnt lgkmcnt(5)
    v_mfma_f32_16x16x32_bf16 v[80:83], v[140:143], v[36:39], v[80:83]
    ds_read_b128 v[132:135], v1 offset:1024
    v_mfma_f32_16x16x32_bf16 v[96:99], v[140:143], v[52:55], v[96:99]
    v_mfma_f32_16x16x32_bf16 v[112:115], v[140:143], v[68:71], v[112:115]
    s_waitcnt lgkmcnt(5)
    v_mfma_f32_16x16x32_bf16 v[80:83], v[144:147], v[40:43], v[80:83]
    ds_read_b128 v[136:139], v2 offset:1024
    v_mfma_f32_16x16x32_bf16 v[96:99], v[144:147], v[56:59], v[96:99]
    v_mfma_f32_16x16x32_bf16 v[112:115], v[144:147], v[72:75], v[112:115]
    v_max3_f32 v11, v76, v77, v78
    v_max3_f32 v9, v108, v109, v110
    v_max3_f32 v8, v92, v93, v94
    s_nop 1
    v_max3_f32 v11, v11, v79, v80
    s_nop 1
    v_max3_f32 v9, v9, v111, v112
    v_max3_f32 v8, v8, v95, v96
    v_max3_f32 v11, v11, v81, v82
    v_max3_f32 v9, v9, v113, v114
    v_max3_f32 v8, v8, v97, v98
    v_max_f32 v11, v11, v83
    v_max_f32 v9, v9, v115
    v_max3_f32 v8, v8, v99, v11
    v_cmp_lt_f32 vcc, s66, v8
    s_cbranch_vccnz k1_ok_7_s
k1_ok_7:
    v_cmp_lt_f32 vcc, s67, v9
    s_cbranch_vccnz k1_ok_8_s
k1_ok_8:
    s_setprio 0
    s_waitcnt lgkmcnt(5)
    v_mfma_f32_16x16x32_bf16 v[84:87], v[116:119], v[28:31], v[16:19]
    v_exp_f32 v76, v76
    v_exp_f32 v92, v92
    ds_read_b128 v[140:143], v1 offset:1536
    v_mfma_f32_16x16x32_bf16 v[100:103], v[116:119], v[44:47], v[20:23]
    v_exp_f32 v108, v108
    v_exp_f32 v77, v77
    s_waitcnt lgkmcnt(5)
    v_mfma_f32_16x16x32_bf16 v[84:87], v[120:123], v[32:35], v[84:87]
    v_add_u32 v1, s62, v1
    v_exp_f32 v93, v93
    ds_read_b128 v[144:147], v2 offset:1536
    v_mfma_f32_16x16x32_bf16 v[100:103], v[120:123], v[48:51], v[100:103]
    v_exp_f32 v109, v109
    v_exp_f32 v78, v78
    s_waitcnt lgkmcnt(5)
    v_mfma_f32_16x16x32_bf16 v[84:87], v[124:127], v[36:39], v[84:87]
    v_add_u32 v2, s62, v2
    v_exp_f32 v94, v94
    v_mfma_f32_16x16x32_bf16 v[100:103], v[124:127], v[52:55], v[100:103]
    v_exp_f32 v110, v110
    v_cvt_pk_bf16_f32 v76, v76, v77
    v_cvt_pk_bf16_f32 v92, v92, v93
    s_waitcnt lgkmcnt(4)
    v_mfma_f32_16x16x32_bf16 v[84:87], v[128:131], v[40:43], v[84:87]
    v_cvt_pk_bf16_f32 v108, v108, v109
    v_exp_f32 v79, v79
    v_mfma_f32_16x16x32_bf16 v[100:103], v[128:131], v[56:59], v[100:103]
    v_exp_f32 v95, v95
    v_exp_f32 v111, v111
    s_waitcnt lgkmcnt(3)
    v_mfma_f32_16x16x32_bf16 v[88:91], v[132:135], v[28:31], v[16:19]
    v_exp_f32 v80, v80
    v_exp_f32 v96, v96
    v_mfma_f32_16x16x32_bf16 v[104:107], v[132:135], v[44:47], v[20:23]
    v_exp_f32 v112, v112
    v_cvt_pk_bf16_f32 v77, v78, v79
    v_cvt_pk_bf16_f32 v93, v94, v95
    s_waitcnt vmcnt(63) lgkmcnt(0)
    s_barrier
    s_setprio 3
    ds_read_b64_tr_b16 v[116:117], v3 offset:0
    ds_read_b64_tr_b16 v[118:119], v3 offset:1024
    ds_read_b64_tr_b16 v[120:121], v4 offset:0
    ds_read_b64_tr_b16 v[122:123], v4 offset:1024
    ds_read_b64_tr_b16 v[124:125], v5 offset:0
    ds_read_b64_tr_b16 v[126:127], v5 offset:1024
    v_mfma_f32_16x16x32_bf16 v[88:91], v[136:139], v[32:35], v[88:91]
    v_cvt_pk_bf16_f32 v109, v110, v111
    v_exp_f32 v81, v81
    ds_read_b64_tr_b16 v[128:129], v6 offset:0
    v_mfma_f32_16x16x32_bf16 v[104:107], v[136:139], v[48:51], v[104:107]
    v_exp_f32 v97, v97
    v_exp_f32 v113, v113
    ds_read_b64_tr_b16 v[130:131], v6 offset:1024
    v_mfma_f32_16x16x32_bf16 v[88:91], v[140:143], v[36:39], v[88:91]
    v_exp_f32 v82, v82
    v_exp_f32 v98, v98
    ds_read_b64_tr_b16 v[132:133], v3 offset:512
    v_mfma_f32_16x16x32_bf16 v[104:107], v[140:143], v[52:55], v[104:107]
    v_exp_f32 v114, v114
    v_cvt_pk_bf16_f32 v78, v80, v81
    v_cvt_pk_bf16_f32 v94, v96, v97
    ds_read_b64_tr_b16 v[134:135], v3 offset:1536
    v_mfma_f32_16x16x32_bf16 v[88:91], v[144:147], v[40:43], v[88:91]
    v_cvt_pk_bf16_f32 v110, v112, v113
    v_exp_f32 v83, v83
    v_exp_f32 v99, v99
    v_exp_f32 v115, v115
    v_cvt_pk_bf16_f32 v79, v82, v83
    v_cvt_pk_bf16_f32 v95, v98, v99
    v_cvt_pk_bf16_f32 v111, v114, v115
    ds_read_b64_tr_b16 v[136:137], v4 offset:512
    v_mfma_f32_16x16x32_bf16 v[104:107], v[144:147], v[56:59], v[104:107]
    ds_read_b64_tr_b16 v[138:139], v4 offset:1536
k1_X:
    s_waitcnt lgkmcnt(10)
    v_mfma_f32_16x16x32_bf16 v[152:155], v[116:119], v[76:79], v[152:155]
    ds_read_b64_tr_b16 v[140:141], v5 offset:512
    s_add_u32 s50, s60, s73
    s_add_u32 s51, s60, s72
    s_cmp_ge_u32 s55, 6
    s_cselect_b32 s51, 196608, s51
    s_cselect_b32 s64, 0x1000000, s64
    s_sub_u32 s3, s55, 1
    s_cmp_ge_u32 s3, 5
    s_cselect_b32 m0, 196608, s50
    s_cselect_b32 s3, 0x1000000, s65
    s_cselect_b32 s4, 0, 16384
    v_mfma_f32_16x16x32_bf16 v[188:191], v[116:119], v[92:95], v[188:191]
    v_max3_f32 v11, v84, v85, v86
    v_max3_f32 v8, v100, v101, v102
    ds_read_b64_tr_b16 v[142:143], v5 offset:1536
    s_mov_b32 s72, s58
    s_cmp_ge_u32 s58, 49152
    s_cselect_b32 s62, 0xffff4000, s57
    s_add_u32 s58, s58, s62
    s_sub_u32 s62, s62, s47
    v_mfma_f32_16x16x32_bf16 v[224:227], v[116:119], v[108:111], v[224:227]
    v_max3_f32 v11, v11, v87, v88
    v_max3_f32 v8, v8, v103, v104
    s_mov_b32 s73, s59
    s_cmp_ge_u32 s59, 49152
    s_cselect_b32 s63, 0xffff4000, s57
    s_add_u32 s59, s59, s63
    s_sub_u32 s63, s63, s47
    s_waitcnt lgkmcnt(10)
    v_mfma_f32_16x16x32_bf16 v[156:159], v[120:123], v[76:79], v[156:159]
    v_add_u32 v3, s47, v3
    v_add_u32 v5, s47, v5
    ds_read_b64_tr_b16 v[144:145], v6 offset:512
    v_mfma_f32_16x16x32_bf16 v[192:195], v[120:123], v[92:95], v[192:195]
    v_max3_f32 v11, v11, v89, v90
    v_max3_f32 v8, v8, v105, v106
    ds_read_b64_tr_b16 v[146:147], v6 offset:1536
    v_mfma_f32_16x16x32_bf16 v[228:231], v[120:123], v[108:111], v[228:231]
    v_max_f32 v11, v11, v91
    v_max3_f32 v8, v8, v107, v11
    s_waitcnt lgkmcnt(10)
    v_mfma_f32_16x16x32_bf16 v[160:163], v[124:127], v[76:79], v[160:163]
    v_add_u32 v4, s47, v4
    v_add_u32 v6, s47, v6
    ds_read_b128 v[116:119], v1 offset:0
    v_mfma_f32_16x16x32_bf16 v[196:199], v[124:127], v[92:95], v[196:199]
    v_cmp_lt_f32 vcc, s66, v8
    s_cbranch_vccnz k1_ok_9_s
k1_ok_9:
    v_mfma_f32_16x16x32_bf16 v[232:235], v[124:127], v[108:111], v[232:235]
    v_exp_f32 v84, v84
    s_waitcnt lgkmcnt(9)
    v_mfma_f32_16x16x32_bf16 v[164:167], v[128:131], v[76:79], v[164:167]
    v_exp_f32 v100, v100
    ds_read_b128 v[120:123], v2 offset:0
    v_mfma_f32_16x16x32_bf16 v[200:203], v[128:131], v[92:95], v[200:203]
    v_mfma_f32_16x16x32_bf16 v[236:239], v[128:131], v[108:111], v[236:239]
    v_exp_f32 v85, v85
    s_waitcnt lgkmcnt(8)
    v_mfma_f32_16x16x32_bf16 v[168:171], v[132:135], v[76:79], v[168:171]
    v_exp_f32 v101, v101
    ds_read_b128 v[124:127], v1 offset:512
    v_mfma_f32_16x16x32_bf16 v[204:207], v[132:135], v[92:95], v[204:207]
    v_mfma_f32_16x16x32_bf16 v[240:243], v[132:135], v[108:111], v[240:243]
    v_exp_f32 v86, v86
    s_waitcnt lgkmcnt(7)
    v_mfma_f32_16x16x32_bf16 v[172:175], v[136:139], v[76:79], v[172:175]
    ds_read_b128 v[128:131], v2 offset:512
    v_mfma_f32_16x16x32_bf16 v[208:211], v[136:139], v[92:95], v[208:211]
    v_exp_f32 v102, v102
    v_mfma_f32_16x16x32_bf16 v[244:247], v[136:139], v[108:111], v[244:247]
    v_cvt_pk_bf16_f32 v84, v84, v85
    v_cvt_pk_bf16_f32 v100, v100, v101
    s_waitcnt lgkmcnt(6)
    v_mfma_f32_16x16x32_bf16 v[176:179], v[140:143], v[76:79], v[176:179]
    ds_read_b128 v[132:135], v1 offset:1024
    v_mfma_f32_16x16x32_bf16 v[212:215], v[140:143], v[92:95], v[212:215]
    v_exp_f32 v87, v87
    v_mfma_f32_16x16x32_bf16 v[248:251], v[140:143], v[108:111], v[248:251]
    v_exp_f32 v103, v103
    s_waitcnt lgkmcnt(5)
    v_mfma_f32_16x16x32_bf16 v[180:183], v[144:147], v[76:79], v[180:183]
    ds_read_b128 v[136:139], v2 offset:1024
    v_mfma_f32_16x16x32_bf16 v[216:219], v[144:147], v[92:95], v[216:219]
    v_exp_f32 v88, v88
    v_mfma_f32_16x16x32_bf16 v[252:255], v[144:147], v[108:111], v[252:255]
    v_mfma_f32_16x16x32_bf16 v[148:151], v[12:15], v[76:79], v[148:151]
    v_exp_f32 v104, v104
    buffer_load_dwordx4 v7, s[28:31], s3 offen offset:0 nt lds
    buffer_load_dwordx4 v7, s[28:31], s3 offen offset:1024 nt lds
    buffer_load_dwordx4 v7, s[28:31], s3 offen offset:2048 nt lds
    buffer_load_dwordx4 v7, s[28:31], s3 offen offset:3072 nt lds
    s_add_u32 s65, s65, s4
    s_mov_b32 m0, s51
    v_mfma_f32_16x16x32_bf16 v[184:187], v[12:15], v[92:95], v[184:187]
    v_cvt_pk_bf16_f32 v85, v86, v87
    v_cvt_pk_bf16_f32 v101, v102, v103
    v_mfma_f32_16x16x32_bf16 v[220:223], v[12:15], v[108:111], v[220:223]
    s_cmp_lg_u32 s46, 0
    s_cbranch_scc1 k1_nors_10_s
k1_nors_10:
    s_setprio 2
    s_waitcnt lgkmcnt(5)
    v_mfma_f32_16x16x32_bf16 v[76:79], v[116:119], v[28:31], v[16:19]
    v_exp_f32 v89, v89
    ds_read_b128 v[140:143], v1 offset:1536
    v_mfma_f32_16x16x32_bf16 v[92:95], v[116:119], v[44:47], v[20:23]
    v_exp_f32 v105, v105
    s_waitcnt lgkmcnt(5)
    v_mfma_f32_16x16x32_bf16 v[76:79], v[120:123], v[32:35], v[76:79]
    v_add_u32 v1, s47, v1
    ds_read_b128 v[144:147], v2 offset:1536
    v_mfma_f32_16x16x32_bf16 v[92:95], v[120:123], v[48:51], v[92:95]
    s_waitcnt lgkmcnt(5)
    v_mfma_f32_16x16x32_bf16 v[76:79], v[124:127], v[36:39], v[76:79]
    v_add_u32 v2, s47, v2
    ds_read_b64_tr_b16 v[116:117], v3 offset:0
    v_mfma_f32_16x16x32_bf16 v[92:95], v[124:127], v[52:55], v[92:95]
    v_exp_f32 v90, v90
    ds_read_b64_tr_b16 v[118:119], v3 offset:1024
    buffer_load_dwordx4 v7, s[32:35], s64 offen offset:0 nt lds
    buffer_load_dwordx4 v7, s[32:35], s64 offen offset:1024 nt lds
    buffer_load_dwordx4 v7, s[32:35], s64 offen offset:2048 nt lds
    buffer_load_dwordx4 v7, s[32:35], s64 offen offset:3072 nt lds
    s_add_u32 s64, s64, 16384
    s_waitcnt lgkmcnt(6)
    v_mfma_f32_16x16x32_bf16 v[76:79], v[128:131], v[40:43], v[76:79]
    ds_read_b64_tr_b16 v[120:121], v4 offset:0
    v_mfma_f32_16x16x32_bf16 v[92:95], v[128:131], v[56:59], v[92:95]
    v_exp_f32 v106, v106
    ds_read_b64_tr_b16 v[122:123], v4 offset:1024
    s_waitcnt lgkmcnt(7)
    v_mfma_f32_16x16x32_bf16 v[80:83], v[132:135], v[28:31], v[16:19]
    v_cvt_pk_bf16_f32 v86, v88, v89
    v_cvt_pk_bf16_f32 v102, v104, v105
    ds_read_b64_tr_b16 v[124:125], v5 offset:0
    v_mfma_f32_16x16x32_bf16 v[96:99], v[132:135], v[44:47], v[20:23]
    ds_read_b64_tr_b16 v[126:127], v5 offset:1024
    s_waitcnt lgkmcnt(8)
    v_mfma_f32_16x16x32_bf16 v[80:83], v[136:139], v[32:35], v[80:83]
    v_exp_f32 v91, v91
    ds_read_b64_tr_b16 v[128:129], v6 offset:0
    v_mfma_f32_16x16x32_bf16 v[96:99], v[136:139], v[48:51], v[96:99]
    v_exp_f32 v107, v107
    ds_read_b64_tr_b16 v[130:131], v6 offset:1024
    s_waitcnt lgkmcnt(9)
    v_mfma_f32_16x16x32_bf16 v[80:83], v[140:143], v[36:39], v[80:83]
    ds_read_b64_tr_b16 v[132:133], v3 offset:512
    v_mfma_f32_16x16x32_bf16 v[96:99], v[140:143], v[52:55], v[96:99]
    v_cvt_pk_bf16_f32 v87, v90, v91
    v_cvt_pk_bf16_f32 v103, v106, v107
    ds_read_b64_tr_b16 v[134:135], v3 offset:1536
    s_waitcnt lgkmcnt(10)
    v_mfma_f32_16x16x32_bf16 v[80:83], v[144:147], v[40:43], v[80:83]
    ds_read_b64_tr_b16 v[136:137], v4 offset:512
    v_mfma_f32_16x16x32_bf16 v[96:99], v[144:147], v[56:59], v[96:99]
    ds_read_b64_tr_b16 v[138:139], v4 offset:1536
    s_setprio 0
    s_waitcnt lgkmcnt(10)
    v_mfma_f32_16x16x32_bf16 v[152:155], v[116:119], v[84:87], v[152:155]
    ds_read_b64_tr_b16 v[140:141], v5 offset:512
    v_mfma_f32_16x16x32_bf16 v[188:191], v[116:119], v[100:103], v[188:191]
    v_max3_f32 v11, v76, v77, v78
    v_max3_f32 v8, v92, v93, v94
    ds_read_b64_tr_b16 v[142:143], v5 offset:1536
    s_waitcnt lgkmcnt(10)
    v_mfma_f32_16x16x32_bf16 v[156:159], v[120:123], v[84:87], v[156:159]
    v_add_u32 v3, s63, v3
    v_add_u32 v5, s63, v5
    ds_read_b64_tr_b16 v[144:145], v6 offset:512
    v_mfma_f32_16x16x32_bf16 v[192:195], v[120:123], v[100:103], v[192:195]
    v_max3_f32 v11, v11, v79, v80
    v_max3_f32 v8, v8, v95, v96
    ds_read_b64_tr_b16 v[146:147], v6 offset:1536
    s_waitcnt lgkmcnt(10)
    v_mfma_f32_16x16x32_bf16 v[160:163], v[124:127], v[84:87], v[160:163]
    v_add_u32 v4, s63, v4
    v_add_u32 v6, s63, v6
    ds_read_b128 v[116:119], v1 offset:0
    v_mfma_f32_16x16x32_bf16 v[196:199], v[124:127], v[100:103], v[196:199]
    v_max3_f32 v11, v11, v81, v82
    v_max3_f32 v8, v8, v97, v98
    s_waitcnt lgkmcnt(9)
    v_mfma_f32_16x16x32_bf16 v[164:167], v[128:131], v[84:87], v[164:167]
    v_max_f32 v11, v11, v83
    v_max3_f32 v8, v8, v99, v11
    ds_read_b128 v[120:123], v2 offset:0
    v_mfma_f32_16x16x32_bf16 v[200:203], v[128:131], v[100:103], v[200:203]
    v_cmp_lt_f32 vcc, s66, v8
    s_cbranch_vccnz k1_ok_11_s
k1_ok_11:
    s_waitcnt lgkmcnt(8)
    v_mfma_f32_16x16x32_bf16 v[168:171], v[132:135], v[84:87], v[168:171]
    v_exp_f32 v76, v76
    ds_read_b128 v[124:127], v1 offset:512
    v_mfma_f32_16x16x32_bf16 v[204:207], v[132:135], v[100:103], v[204:207]
    v_exp_f32 v92, v92
    s_waitcnt lgkmcnt(7)
    v_mfma_f32_16x16x32_bf16 v[172:175], v[136:139], v[84:87], v[172:175]
    v_exp_f32 v77, v77
    ds_read_b128 v[128:131], v2 offset:512
    v_mfma_f32_16x16x32_bf16 v[208:211], v[136:139], v[100:103], v[208:211]
    v_exp_f32 v93, v93
    s_waitcnt lgkmcnt(6)
    v_mfma_f32_16x16x32_bf16 v[176:179], v[140:143], v[84:87], v[176:179]
    v_exp_f32 v78, v78
    ds_read_b128 v[132:135], v1 offset:1024
    v_mfma_f32_16x16x32_bf16 v[212:215], v[140:143], v[100:103], v[212:215]
    v_exp_f32 v94, v94
    s_waitcnt lgkmcnt(5)
    v_mfma_f32_16x16x32_bf16 v[180:183], v[144:147], v[84:87], v[180:183]
    v_cvt_pk_bf16_f32 v76, v76, v77
    v_cvt_pk_bf16_f32 v92, v92, v93
    ds_read_b128 v[136:139], v2 offset:1024
    v_mfma_f32_16x16x32_bf16 v[216:219], v[144:147], v[100:103], v[216:219]
    v_mfma_f32_16x16x32_bf16 v[148:151], v[12:15], v[84:87], v[148:151]
    v_exp_f32 v79, v79
    v_mfma_f32_16x16x32_bf16 v[184:187], v[12:15], v[100:103], v[184:187]
    v_exp_f32 v95, v95
    s_cmp_lg_u32 s46, 0
    s_cbranch_scc1 k1_nors_12_s
k1_nors_12:
    s_setprio 0
    s_waitcnt lgkmcnt(5)
    v_mfma_f32_16x16x32_bf16 v[84:87], v[116:119], v[28:31], v[16:19]
    v_exp_f32 v80, v80
    ds_read_b128 v[140:143], v1 offset:1536
    v_mfma_f32_16x16x32_bf16 v[100:103], v[116:119], v[44:47], v[20:23]
    v_exp_f32 v96, v96
    s_waitcnt lgkmcnt(5)
    v_mfma_f32_16x16x32_bf16 v[84:87], v[120:123], v[32:35], v[84:87]
    v_add_u32 v1, s62, v1
    ds_read_b128 v[144:147], v2 offset:1536
    v_mfma_f32_16x16x32_bf16 v[100:103], v[120:123], v[48:51], v[100:103]
    v_cvt_pk_bf16_f32 v77, v78, v79
    v_cvt_pk_bf16_f32 v93, v94, v95
    s_waitcnt lgkmcnt(5)
    v_mfma_f32_16x16x32_bf16 v[84:87], v[124:127], v[36:39], v[84:87]
    v_add_u32 v2, s62, v2
    v_mfma_f32_16x16x32_bf16 v[100:103], v[124:127], v[52:55], v[100:103]
    v_exp_f32 v81, v81
    s_waitcnt lgkmcnt(4)
    v_mfma_f32_16x16x32_bf16 v[84:87], v[128:131], v[40:43], v[84:87]
    v_exp_f32 v97, v97
    v_mfma_f32_16x16x32_bf16 v[100:103], v[128:131], v[56:59], v[100:103]
    s_waitcnt lgkmcnt(3)
    v_mfma_f32_16x16x32_bf16 v[88:91], v[132:135], v[28:31], v[16:19]
    v_exp_f32 v82, v82
    v_mfma_f32_16x16x32_bf16 v[104:107], v[132:135], v[44:47], v[20:23]
    v_exp_f32 v98, v98
    s_waitcnt vmcnt(4) lgkmcnt(0)
    s_barrier
    s_setprio 3
    ds_read_b64_tr_b16 v[116:117], v3 offset:0
    ds_read_b64_tr_b16 v[118:119], v3 offset:1024
    ds_read_b64_tr_b16 v[120:121], v4 offset:0
    ds_read_b64_tr_b16 v[122:123], v4 offset:1024
    ds_read_b64_tr_b16 v[124:125], v5 offset:0
    ds_read_b64_tr_b16 v[126:127], v5 offset:1024
    v_mfma_f32_16x16x32_bf16 v[88:91], v[136:139], v[32:35], v[88:91]
    v_cvt_pk_bf16_f32 v78, v80, v81
    v_cvt_pk_bf16_f32 v94, v96, v97
    ds_read_b64_tr_b16 v[128:129], v6 offset:0
    v_mfma_f32_16x16x32_bf16 v[104:107], v[136:139], v[48:51], v[104:107]
    v_exp_f32 v83, v83
    ds_read_b64_tr_b16 v[130:131], v6 offset:1024
    v_mfma_f32_16x16x32_bf16 v[88:91], v[140:143], v[36:39], v[88:91]
    v_exp_f32 v99, v99
    ds_read_b64_tr_b16 v[132:133], v3 offset:512
    v_mfma_f32_16x16x32_bf16 v[104:107], v[140:143], v[52:55], v[104:107]
    v_cvt_pk_bf16_f32 v79, v82, v83
    v_cvt_pk_bf16_f32 v95, v98, v99
    ds_read_b64_tr_b16 v[134:135], v3 offset:1536
    v_mfma_f32_16x16x32_bf16 v[88:91], v[144:147], v[40:43], v[88:91]
    ds_read_b64_tr_b16 v[136:137], v4 offset:512
    v_mfma_f32_16x16x32_bf16 v[104:107], v[144:147], v[56:59], v[104:107]
    ds_read_b64_tr_b16 v[138:139], v4 offset:1536
    s_add_u32 s55, s55, 1
    s_cmp_eq_u32 s55, 7
    s_cbranch_scc1 k1_finL
k1_Y:
    s_waitcnt lgkmcnt(10)
    v_mfma_f32_16x16x32_bf16 v[152:155], v[116:119], v[76:79], v[152:155]
    ds_read_b64_tr_b16 v[140:141], v5 offset:512
    s_add_u32 s50, s60, s73
    s_add_u32 s51, s60, s72
    s_cmp_ge_u32 s55, 6
    s_cselect_b32 s51, 196608, s51
    s_cselect_b32 s64, 0x1000000, s64
    s_sub_u32 s3, s55, 1
    s_cmp_ge_u32 s3, 5
    s_cselect_b32 m0, 196608, s50
    s_cselect_b32 s3, 0x1000000, s65
    s_cselect_b32 s4, 0, 16384
    v_mfma_f32_16x16x32_bf16 v[188:191], v[116:119], v[92:95], v[188:191]
    v_max3_f32 v11, v84, v85, v86
    v_max3_f32 v8, v100, v101, v102
    ds_read_b64_tr_b16 v[142:143], v5 offset:1536
    s_mov_b32 s72, s58
    s_cmp_ge_u32 s58, 49152
    s_cselect_b32 s62, 0xffff4000, s57
    s_add_u32 s58, s58, s62
    s_sub_u32 s62, s62, s47
    s_waitcnt lgkmcnt(10)
    v_mfma_f32_16x16x32_bf16 v[156:159], v[120:123], v[76:79], v[156:159]
    v_add_u32 v3, s47, v3
    v_add_u32 v5, s47, v5
    ds_read_b64_tr_b16 v[144:145], v6 offset:512
    s_mov_b32 s73, s59
    s_cmp_ge_u32 s59, 49152
    s_cselect_b32 s63, 0xffff4000, s57
    s_add_u32 s59, s59, s63
    s_sub_u32 s63, s63, s47
    v_mfma_f32_16x16x32_bf16 v[192:195], v[120:123], v[92:95], v[192:195]
    v_max3_f32 v11, v11, v87, v88
    v_max3_f32 v8, v8, v103, v104
    ds_read_b64_tr_b16 v[146:147], v6 offset:1536
    s_waitcnt lgkmcnt(10)
    v_mfma_f32_16x16x32_bf16 v[160:163], v[124:127], v[76:79], v[160:163]
    v_add_u32 v4, s47, v4
    v_add_u32 v6, s47, v6
    ds_read_b128 v[116:119], v1 offset:0
    v_mfma_f32_16x16x32_bf16 v[196:199], v[124:127], v[92:95], v[196:199]
    v_max3_f32 v11, v11, v89, v90
    v_max3_f32 v8, v8, v105, v106
    s_waitcnt lgkmcnt(9)
    v_mfma_f32_16x16x32_bf16 v[164:167], v[128:131], v[76:79], v[164:167]
    v_max_f32 v11, v11, v91
    v_max3_f32 v8, v8, v107, v11
    ds_read_b128 v[120:123], v2 offset:0
    v_mfma_f32_16x16x32_bf16 v[200:203], v[128:131], v[92:95], v[200:203]
    v_cmp_lt_f32 vcc, s66, v8
    s_cbranch_vccnz k1_ok_13_s
k1_ok_13:
    s_waitcnt lgkmcnt(8)
    v_mfma_f32_16x16x32_bf16 v[168:171], v[132:135], v[76:79], v[168:171]
    v_exp_f32 v84, v84
    ds_read_b128 v[124:127], v1 offset:512
    v_mfma_f32_16x16x32_bf16 v[204:207], v[132:135], v[92:95], v[204:207]
    v_exp_f32 v100, v100
    s_waitcnt lgkmcnt(7)
    v_mfma_f32_16x16x32_bf16 v[172:175], v[136:139], v[76:79], v[172:175]
    ds_read_b128 v[128:131], v2 offset:512
    v_mfma_f32_16x16x32_bf16 v[208:211], v[136:139], v[92:95], v[208:211]
    v_exp_f32 v85, v85
    s_waitcnt lgkmcnt(6)
    v_mfma_f32_16x16x32_bf16 v[176:179], v[140:143], v[76:79], v[176:179]
    v_exp_f32 v101, v101
    ds_read_b128 v[132:135], v1 offset:1024
    v_mfma_f32_16x16x32_bf16 v[212:215], v[140:143], v[92:95], v[212:215]
    s_waitcnt lgkmcnt(5)
    v_mfma_f32_16x16x32_bf16 v[180:183], v[144:147], v[76:79], v[180:183]
    v_exp_f32 v86, v86
    ds_read_b128 v[136:139], v2 offset:1024
    v_mfma_f32_16x16x32_bf16 v[216:219], v[144:147], v[92:95], v[216:219]
    v_exp_f32 v102, v102
    v_mfma_f32_16x16x32_bf16 v[148:151], v[12:15], v[76:79], v[148:151]
    v_mfma_f32_16x16x32_bf16 v[184:187], v[12:15], v[92:95], v[184:187]
    v_cvt_pk_bf16_f32 v84, v84, v85
    v_cvt_pk_bf16_f32 v100, v100, v101
    s_cmp_lg_u32 s46, 0
    s_cbranch_scc1 k1_nors_14_s
k1_nors_14:
    s_setprio 2
    s_waitcnt lgkmcnt(5)
    v_mfma_f32_16x16x32_bf16 v[76:79], v[116:119], v[28:31], v[16:19]
    v_exp_f32 v87, v87
    ds_read_b128 v[140:143], v1 offset:1536
    v_mfma_f32_16x16x32_bf16 v[92:95], v[116:119], v[44:47], v[20:23]
    v_mfma_f32_16x16x32_bf16 v[108:111], v[116:119], v[60:63], v[24:27]
    v_exp_f32 v103, v103
    s_waitcnt lgkmcnt(5)
    v_mfma_f32_16x16x32_bf16 v[76:79], v[120:123], v[32:35], v[76:79]
    v_add_u32 v1, s47, v1
    ds_read_b128 v[144:147], v2 offset:1536
    v_mfma_f32_16x16x32_bf16 v[92:95], v[120:123], v[48:51], v[92:95]
    v_exp_f32 v88, v88
    v_mfma_f32_16x16x32_bf16 v[108:111], v[120:123], v[64:67], v[108:111]
    s_waitcnt lgkmcnt(5)
    v_mfma_f32_16x16x32_bf16 v[76:79], v[124:127], v[36:39], v[76:79]
    v_add_u32 v2, s47, v2
    ds_read_b64_tr_b16 v[116:117], v3 offset:0
    buffer_load_dwordx4 v7, s[28:31], s3 offen offset:0 nt lds
    buffer_load_dwordx4 v7, s[28:31], s3 offen offset:1024 nt lds
    buffer_load_dwordx4 v7, s[28:31], s3 offen offset:2048 nt lds
    buffer_load_dwordx4 v7, s[28:31], s3 offen offset:3072 nt lds
    s_add_u32 s65, s65, s4
    s_mov_b32 m0, s51
    v_mfma_f32_16x16x32_bf16 v[92:95], v[124:127], v[52:55], v[92:95]
    v_exp_f32 v104, v104
    ds_read_b64_tr_b16 v[118:119], v3 offset:1024
    v_mfma_f32_16x16x32_bf16 v[108:111], v[124:127], v[68:71], v[108:111]
    s_waitcnt lgkmcnt(6)
    v_mfma_f32_16x16x32_bf16 v[76:79], v[128:131], v[40:43], v[76:79]
    v_cvt_pk_bf16_f32 v85, v86, v87
    v_cvt_pk_bf16_f32 v101, v102, v103
    ds_read_b64_tr_b16 v[120:121], v4 offset:0
    v_mfma_f32_16x16x32_bf16 v[92:95], v[128:131], v[56:59], v[92:95]
    v_exp_f32 v89, v89
    ds_read_b64_tr_b16 v[122:123], v4 offset:1024
    v_mfma_f32_16x16x32_bf16 v[108:111], v[128:131], v[72:75], v[108:111]
    s_waitcnt lgkmcnt(7)
    v_mfma_f32_16x16x32_bf16 v[80:83], v[132:135], v[28:31], v[16:19]
    v_exp_f32 v105, v105
    ds_read_b64_tr_b16 v[124:125], v5 offset:0
    v_mfma_f32_16x16x32_bf16 v[96:99], v[132:135], v[44:47], v[20:23]
    v_exp_f32 v90, v90
    ds_read_b64_tr_b16 v[126:127], v5 offset:1024
    v_mfma_f32_16x16x32_bf16 v[112:115], v[132:135], v[60:63], v[24:27]
    buffer_load_dwordx4 v7, s[32:35], s64 offen offset:0 nt lds
    buffer_load_dwordx4 v7, s[32:35], s64 offen offset:1024 nt lds
    buffer_load_dwordx4 v7, s[32:35], s64 offen offset:2048 nt lds
    buffer_load_dwordx4 v7, s[32:35], s64 offen offset:3072 nt lds
    s_add_u32 s64, s64, 16384
    s_waitcnt lgkmcnt(8)
    v_mfma_f32_16x16x32_bf16 v[80:83], v[136:139], v[32:35], v[80:83]
    v_exp_f32 v106, v106
    ds_read_b64_tr_b16 v[128:129], v6 offset:0
    v_mfma_f32_16x16x32_bf16 v[96:99], v[136:139], v[48:51], v[96:99]
    v_cvt_pk_bf16_f32 v86, v88, v89
    v_cvt_pk_bf16_f32 v102, v104, v105
    ds_read_b64_tr_b16 v[130:131], v6 offset:1024
    v_mfma_f32_16x16x32_bf16 v[112:115], v[136:139], v[64:67], v[112:115]
    s_waitcnt lgkmcnt(9)
    v_mfma_f32_16x16x32_bf16 v[80:83], v[140:143], v[36:39], v[80:83]
    v_exp_f32 v91, v91
    ds_read_b64_tr_b16 v[132:133], v3 offset:512
    v_mfma_f32_16x16x32_bf16 v[96:99], v[140:143], v[52:55], v[96:99]
    v_exp_f32 v107, v107
    ds_read_b64_tr_b16 v[134:135], v3 offset:1536
    v_mfma_f32_16x16x32_bf16 v[112:115], v[140:143], v[68:71], v[112:115]
    s_waitcnt lgkmcnt(10)
    v_mfma_f32_16x16x32_bf16 v[80:83], v[144:147], v[40:43], v[80:83]
    v_cvt_pk_bf16_f32 v87, v90, v91
    v_cvt_pk_bf16_f32 v103, v106, v107
    ds_read_b64_tr_b16 v[136:137], v4 offset:512
    v_mfma_f32_16x16x32_bf16 v[96:99], v[144:147], v[56:59], v[96:99]
    ds_read_b64_tr_b16 v[138:139], v4 offset:1536
    v_mfma_f32_16x16x32_bf16 v[112:115], v[144:147], v[72:75], v[112:115]
    s_setprio 1
    s_waitcnt lgkmcnt(10)
    v_mfma_f32_16x16x32_bf16 v[152:155], v[116:119], v[84:87], v[152:155]
    ds_read_b64_tr_b16 v[140:141], v5 offset:512
    v_mfma_f32_16x16x32_bf16 v[188:191], v[116:119], v[100:103], v[188:191]
    v_max3_f32 v11, v76, v77, v78
    v_max3_f32 v9, v108, v109, v110
    v_max3_f32 v8, v92, v93, v94
    v_max3_f32 v11, v11, v79, v80
    ds_read_b64_tr_b16 v[142:143], v5 offset:1536
    s_waitcnt lgkmcnt(10)
    v_mfma_f32_16x16x32_bf16 v[156:159], v[120:123], v[84:87], v[156:159]
    v_add_u32 v3, s63, v3
    v_add_u32 v5, s63, v5
    ds_read_b64_tr_b16 v[144:145], v6 offset:512
    v_mfma_f32_16x16x32_bf16 v[192:195], v[120:123], v[100:103], v[192:195]
    v_max3_f32 v9, v9, v111, v112
    v_max3_f32 v8, v8, v95, v96
    ds_read_b64_tr_b16 v[146:147], v6 offset:1536
    s_waitcnt lgkmcnt(10)
    v_mfma_f32_16x16x32_bf16 v[160:163], v[124:127], v[84:87], v[160:163]
    v_add_u32 v4, s63, v4
    v_add_u32 v6, s63, v6
    v_max3_f32 v11, v11, v81, v82
    v_max3_f32 v9, v9, v113, v114
    ds_read_b128 v[116:119], v1 offset:0
    v_mfma_f32_16x16x32_bf16 v[196:199], v[124:127], v[100:103], v[196:199]
    v_max3_f32 v8, v8, v97, v98
    v_max_f32 v11, v11, v83
    s_waitcnt lgkmcnt(9)
    v_mfma_f32_16x16x32_bf16 v[164:167], v[128:131], v[84:87], v[164:167]
    v_max_f32 v9, v9, v115
    v_max3_f32 v8, v8, v99, v11
    ds_read_b128 v[120:123], v2 offset:0
    v_mfma_f32_16x16x32_bf16 v[200:203], v[128:131], v[100:103], v[200:203]
    v_cmp_lt_f32 vcc, s66, v8
    s_cbranch_vccnz k1_ok_15_s
k1_ok_15:
    v_cmp_lt_f32 vcc, s67, v9
    s_cbranch_vccnz k1_ok_16_s
k1_ok_16:
    v_exp_f32 v76, v76
    s_waitcnt lgkmcnt(8)
    v_mfma_f32_16x16x32_bf16 v[168:171], v[132:135], v[84:87], v[168:171]
    v_exp_f32 v92, v92
    ds_read_b128 v[124:127], v1 offset:512
    v_mfma_f32_16x16x32_bf16 v[204:207], v[132:135], v[100:103], v[204:207]
    v_exp_f32 v108, v108
    s_waitcnt lgkmcnt(7)
    v_mfma_f32_16x16x32_bf16 v[172:175], v[136:139], v[84:87], v[172:175]
    v_exp_f32 v77, v77
    v_exp_f32 v93, v93
    ds_read_b128 v[128:131], v2 offset:512
    v_mfma_f32_16x16x32_bf16 v[208:211], v[136:139], v[100:103], v[208:211]
    v_exp_f32 v109, v109
    s_waitcnt lgkmcnt(6)
    v_mfma_f32_16x16x32_bf16 v[176:179], v[140:143], v[84:87], v[176:179]
    v_exp_f32 v78, v78
    ds_read_b128 v[132:135], v1 offset:1024
    v_mfma_f32_16x16x32_bf16 v[212:215], v[140:143], v[100:103], v[212:215]
    v_exp_f32 v94, v94
    v_exp_f32 v110, v110
    s_waitcnt lgkmcnt(5)
    v_mfma_f32_16x16x32_bf16 v[180:183], v[144:147], v[84:87], v[180:183]
    v_cvt_pk_bf16_f32 v76, v76, v77
    v_cvt_pk_bf16_f32 v92, v92, v93
    ds_read_b128 v[136:139], v2 offset:1024
    v_mfma_f32_16x16x32_bf16 v[216:219], v[144:147], v[100:103], v[216:219]
    v_cvt_pk_bf16_f32 v108, v108, v109
    v_mfma_f32_16x16x32_bf16 v[148:151], v[12:15], v[84:87], v[148:151]
    v_exp_f32 v79, v79
    v_mfma_f32_16x16x32_bf16 v[184:187], v[12:15], v[100:103], v[184:187]
    v_exp_f32 v95, v95
    v_exp_f32 v111, v111
    s_cmp_lg_u32 s46, 0
    s_cbranch_scc1 k1_nors_17_s
k1_nors_17:
    s_setprio 1
    s_waitcnt lgkmcnt(5)
    v_mfma_f32_16x16x32_bf16 v[84:87], v[116:119], v[28:31], v[16:19]
    v_exp_f32 v80, v80
    ds_read_b128 v[140:143], v1 offset:1536
    v_mfma_f32_16x16x32_bf16 v[100:103], v[116:119], v[44:47], v[20:23]
    v_exp_f32 v96, v96
    s_waitcnt lgkmcnt(5)
    v_mfma_f32_16x16x32_bf16 v[84:87], v[120:123], v[32:35], v[84:87]
    v_add_u32 v1, s62, v1
    v_exp_f32 v112, v112
    v_cvt_pk_bf16_f32 v77, v78, v79
    ds_read_b128 v[144:147], v2 offset:1536
    v_mfma_f32_16x16x32_bf16 v[100:103], v[120:123], v[48:51], v[100:103]
    v_cvt_pk_bf16_f32 v93, v94, v95
    v_cvt_pk_bf16_f32 v109, v110, v111
    s_waitcnt lgkmcnt(5)
    v_mfma_f32_16x16x32_bf16 v[84:87], v[124:127], v[36:39], v[84:87]
    v_add_u32 v2, s62, v2
    v_mfma_f32_16x16x32_bf16 v[100:103], v[124:127], v[52:55], v[100:103]
    v_exp_f32 v81, v81
    v_exp_f32 v97, v97
    s_waitcnt lgkmcnt(4)
    v_mfma_f32_16x16x32_bf16 v[84:87], v[128:131], v[40:43], v[84:87]
    v_exp_f32 v113, v113
    v_mfma_f32_16x16x32_bf16 v[100:103], v[128:131], v[56:59], v[100:103]
    v_exp_f32 v82, v82
    s_waitcnt lgkmcnt(3)
    v_mfma_f32_16x16x32_bf16 v[88:91], v[132:135], v[28:31], v[16:19]
    v_exp_f32 v98, v98
    v_exp_f32 v114, v114
    v_mfma_f32_16x16x32_bf16 v[104:107], v[132:135], v[44:47], v[20:23]
    v_cvt_pk_bf16_f32 v78, v80, v81
    v_cvt_pk_bf16_f32 v94, v96, v97
    s_waitcnt vmcnt(4) lgkmcnt(0)
    s_barrier
    s_setprio 3
    ds_read_b64_tr_b16 v[116:117], v3 offset:0
    ds_read_b64_tr_b16 v[118:119], v3 offset:1024
    ds_read_b64_tr_b16 v[120:121], v4 offset:0
    ds_read_b64_tr_b16 v[122:123], v4 offset:1024
    ds_read_b64_tr_b16 v[124:125], v5 offset:0
    ds_read_b64_tr_b16 v[126:127], v5 offset:1024
    v_mfma_f32_16x16x32_bf16 v[88:91], v[136:139], v[32:35], v[88:91]
    v_cvt_pk_bf16_f32 v110, v112, v113
    ds_read_b64_tr_b16 v[128:129], v6 offset:0
    v_mfma_f32_16x16x32_bf16 v[104:107], v[136:139], v[48:51], v[104:107]
    v_exp_f32 v83, v83
    v_exp_f32 v99, v99
    ds_read_b64_tr_b16 v[130:131], v6 offset:1024
    v_mfma_f32_16x16x32_bf16 v[88:91], v[140:143], v[36:39], v[88:91]
    v_exp_f32 v115, v115
    ds_read_b64_tr_b16 v[132:133], v3 offset:512
    v_mfma_f32_16x16x32_bf16 v[104:107], v[140:143], v[52:55], v[104:107]
    v_cvt_pk_bf16_f32 v79, v82, v83
    v_cvt_pk_bf16_f32 v95, v98, v99
    ds_read_b64_tr_b16 v[134:135], v3 offset:1536
    v_mfma_f32_16x16x32_bf16 v[88:91], v[144:147], v[40:43], v[88:91]
    v_cvt_pk_bf16_f32 v111, v114, v115
    ds_read_b64_tr_b16 v[136:137], v4 offset:512
    v_mfma_f32_16x16x32_bf16 v[104:107], v[144:147], v[56:59], v[104:107]
    ds_read_b64_tr_b16 v[138:139], v4 offset:1536
    s_add_u32 s55, s55, 1
    s_cmp_eq_u32 s55, 7
    s_cbranch_scc1 k1_finH
    s_branch k1_X
k1_proL:
    s_waitcnt lgkmcnt(5)
    v_mfma_f32_16x16x32_bf16 v[76:79], v[116:119], v[28:31], v[16:19]
    ds_read_b128 v[140:143], v1 offset:1536
    s_mov_b32 s72, s58
    s_cmp_ge_u32 s58, 49152
    s_cselect_b32 s62, 0xffff4000, s57
    s_add_u32 s58, s58, s62
    s_sub_u32 s62, s62, s47
    v_mfma_f32_16x16x32_bf16 v[92:95], v[116:119], v[44:47], v[20:23]
    s_waitcnt lgkmcnt(5)
    v_mfma_f32_16x16x32_bf16 v[76:79], v[120:123], v[32:35], v[76:79]
    v_add_u32 v1, s47, v1
    ds_read_b128 v[144:147], v2 offset:1536
    v_mfma_f32_16x16x32_bf16 v[92:95], v[120:123], v[48:51], v[92:95]
    s_waitcnt lgkmcnt(5)
    v_mfma_f32_16x16x32_bf16 v[76:79], v[124:127], v[36:39], v[76:79]
    v_add_u32 v2, s47, v2
    ds_read_b128 v[116:119], v1 offset:0
    v_mfma_f32_16x16x32_bf16 v[92:95], v[124:127], v[52:55], v[92:95]
    s_waitcnt lgkmcnt(5)
    v_mfma_f32_16x16x32_bf16 v[76:79], v[128:131], v[40:43], v[76:79]
    ds_read_b128 v[120:123], v2 offset:0
    v_mfma_f32_16x16x32_bf16 v[92:95], v[128:131], v[56:59], v[92:95]
    s_waitcnt lgkmcnt(5)
    v_mfma_f32_16x16x32_bf16 v[80:83], v[132:135], v[28:31], v[16:19]
    ds_read_b128 v[124:127], v1 offset:512
    v_mfma_f32_16x16x32_bf16 v[96:99], v[132:135], v[44:47], v[20:23]
    s_waitcnt lgkmcnt(5)
    v_mfma_f32_16x16x32_bf16 v[80:83], v[136:139], v[32:35], v[80:83]
    ds_read_b128 v[128:131], v2 offset:512
    v_mfma_f32_16x16x32_bf16 v[96:99], v[136:139], v[48:51], v[96:99]
    s_waitcnt lgkmcnt(5)
    v_mfma_f32_16x16x32_bf16 v[80:83], v[140:143], v[36:39], v[80:83]
    ds_read_b128 v[132:135], v1 offset:1024
    v_mfma_f32_16x16x32_bf16 v[96:99], v[140:143], v[52:55], v[96:99]
    s_waitcnt lgkmcnt(5)
    v_mfma_f32_16x16x32_bf16 v[80:83], v[144:147], v[40:43], v[80:83]
    ds_read_b128 v[136:139], v2 offset:1024
    v_mfma_f32_16x16x32_bf16 v[96:99], v[144:147], v[56:59], v[96:99]
    v_max3_f32 v11, v76, v77, v78
    v_max3_f32 v8, v92, v93, v94
    s_nop 3
    v_max3_f32 v11, v11, v79, v80
    s_nop 0
    v_max3_f32 v8, v8, v95, v96
    v_max3_f32 v11, v11, v81, v82
    v_max3_f32 v8, v8, v97, v98
    v_max_f32 v11, v11, v83
    v_max3_f32 v8, v8, v99, v11
    v_cmp_lt_f32 vcc, s66, v8
    s_cbranch_vccnz k1_ok_18_s
k1_ok_18:
    s_setprio 0
    s_waitcnt lgkmcnt(5)
    v_mfma_f32_16x16x32_bf16 v[84:87], v[116:119], v[28:31], v[16:19]
    v_exp_f32 v76, v76
    v_exp_f32 v92, v92
    ds_read_b128 v[140:143], v1 offset:1536
    v_mfma_f32_16x16x32_bf16 v[100:103], v[116:119], v[44:47], v[20:23]
    v_exp_f32 v77, v77
    s_waitcnt lgkmcnt(5)
    v_mfma_f32_16x16x32_bf16 v[84:87], v[120:123], v[32:35], v[84:87]
    v_add_u32 v1, s62, v1
    v_exp_f32 v93, v93
    ds_read_b128 v[144:147], v2 offset:1536
    v_mfma_f32_16x16x32_bf16 v[100:103], v[120:123], v[48:51], v[100:103]
    v_exp_f32 v78, v78
    s_waitcnt lgkmcnt(5)
    v_mfma_f32_16x16x32_bf16 v[84:87], v[124:127], v[36:39], v[84:87]
    v_add_u32 v2, s62, v2
    v_exp_f32 v94, v94
    v_cvt_pk_bf16_f32 v76, v76, v77
    v_mfma_f32_16x16x32_bf16 v[100:103], v[124:127], v[52:55], v[100:103]
    v_cvt_pk_bf16_f32 v92, v92, v93
    s_waitcnt lgkmcnt(4)
    v_mfma_f32_16x16x32_bf16 v[84:87], v[128:131], v[40:43], v[84:87]
    v_exp_f32 v79, v79
    v_exp_f32 v95, v95
    v_mfma_f32_16x16x32_bf16 v[100:103], v[128:131], v[56:59], v[100:103]
    v_exp_f32 v80, v80
    s_waitcnt lgkmcnt(3)
    v_mfma_f32_16x16x32_bf16 v[88:91], v[132:135], v[28:31], v[16:19]
    v_exp_f32 v96, v96
    v_cvt_pk_bf16_f32 v77, v78, v79
    v_cvt_pk_bf16_f32 v93, v94, v95
    v_mfma_f32_16x16x32_bf16 v[104:107], v[132:135], v[44:47], v[20:23]
    v_exp_f32 v81, v81
    s_waitcnt vmcnt(63) lgkmcnt(0)
    s_barrier
    s_setprio 3
    ds_read_b64_tr_b16 v[116:117], v3 offset:0
    ds_read_b64_tr_b16 v[118:119], v3 offset:1024
    ds_read_b64_tr_b16 v[120:121], v4 offset:0
    ds_read_b64_tr_b16 v[122:123], v4 offset:1024
    ds_read_b64_tr_b16 v[124:125], v5 offset:0
    ds_read_b64_tr_b16 v[126:127], v5 offset:1024
    v_mfma_f32_16x16x32_bf16 v[88:91], v[136:139], v[32:35], v[88:91]
    v_exp_f32 v97, v97
    v_exp_f32 v82, v82
    ds_read_b64_tr_b16 v[128:129], v6 offset:0
    v_mfma_f32_16x16x32_bf16 v[104:107], v[136:139], v[48:51], v[104:107]
    v_exp_f32 v98, v98
    ds_read_b64_tr_b16 v[130:131], v6 offset:1024
    v_mfma_f32_16x16x32_bf16 v[88:91], v[140:143], v[36:39], v[88:91]
    v_cvt_pk_bf16_f32 v78, v80, v81
    v_cvt_pk_bf16_f32 v94, v96, v97
    v_exp_f32 v83, v83
    ds_read_b64_tr_b16 v[132:133], v3 offset:512
    v_mfma_f32_16x16x32_bf16 v[104:107], v[140:143], v[52:55], v[104:107]
    v_exp_f32 v99, v99
    ds_read_b64_tr_b16 v[134:135], v3 offset:1536
    v_mfma_f32_16x16x32_bf16 v[88:91], v[144:147], v[40:43], v[88:91]
    v_cvt_pk_bf16_f32 v79, v82, v83
    v_cvt_pk_bf16_f32 v95, v98, v99
    ds_read_b64_tr_b16 v[136:137], v4 offset:512
    v_mfma_f32_16x16x32_bf16 v[104:107], v[144:147], v[56:59], v[104:107]
    ds_read_b64_tr_b16 v[138:139], v4 offset:1536
    s_branch k1_Y
k1_rare0:
    v_max3_f32 v11, v76, v77, v78
    v_max3_f32 v11, v11, v79, v80
    v_max3_f32 v11, v11, v81, v82
    v_max_f32 v11, v11, v83
    v_mov_b32 v8, v11
    s_nop 1
    v_permlane32_swap_b32 v11, v8
    v_max_f32 v11, v11, v8
    v_mov_b32 v8, v11
    s_nop 1
    v_permlane16_swap_b32 v11, v8
    v_max_f32 v11, v11, v8
    v_max_f32 v11, s68, v11
    v_sub_f32 v76, v76, v11
    v_sub_f32 v77, v77, v11
    v_sub_f32 v78, v78, v11
    v_sub_f32 v79, v79, v11
    v_sub_f32 v80, v80, v11
    v_sub_f32 v81, v81, v11
    v_sub_f32 v82, v82, v11
    v_sub_f32 v83, v83, v11
    v_sub_f32 v16, v16, v11
    v_sub_f32 v17, v17, v11
    v_sub_f32 v18, v18, v11
    v_sub_f32 v19, v19, v11
    s_cmp_lg_u32 s68, 0
    s_cbranch_scc1 k1_first_19
    v_exp_f32 v8, -v11
    s_mov_b32 s46, 1
k1_first_19:
    v_max3_f32 v11, v92, v93, v94
    v_max3_f32 v11, v11, v95, v96
    v_max3_f32 v11, v11, v97, v98
    v_max_f32 v11, v11, v99
    v_mov_b32 v10, v11
    s_nop 1
    v_permlane32_swap_b32 v11, v10
    v_max_f32 v11, v11, v10
    v_mov_b32 v10, v11
    s_nop 1
    v_permlane16_swap_b32 v11, v10
    v_max_f32 v11, v11, v10
    v_max_f32 v11, s68, v11
    v_sub_f32 v92, v92, v11
    v_sub_f32 v93, v93, v11
    v_sub_f32 v94, v94, v11
    v_sub_f32 v95, v95, v11
    v_sub_f32 v96, v96, v11
    v_sub_f32 v97, v97, v11
    v_sub_f32 v98, v98, v11
    v_sub_f32 v99, v99, v11
    v_sub_f32 v20, v20, v11
    v_sub_f32 v21, v21, v11
    v_sub_f32 v22, v22, v11
    v_sub_f32 v23, v23, v11
    s_cmp_lg_u32 s68, 0
    s_cbranch_scc1 k1_first_21
    v_exp_f32 v10, -v11
    s_mov_b32 s46, 1
k1_first_21:
    s_mov_b32 s66, 0x41000000
    s_mov_b32 s68, 0
    s_setpc_b64 s[6:7]
k1_rare1:
    v_max3_f32 v11, v84, v85, v86
    v_max3_f32 v11, v11, v87, v88
    v_max3_f32 v11, v11, v89, v90
    v_max_f32 v11, v11, v91
    v_mov_b32 v8, v11
    s_nop 1
    v_permlane32_swap_b32 v11, v8
    v_max_f32 v11, v11, v8
    v_mov_b32 v8, v11
    s_nop 1
    v_permlane16_swap_b32 v11, v8
    v_max_f32 v11, v11, v8
    v_max_f32 v11, s68, v11
    v_sub_f32 v84, v84, v11
    v_sub_f32 v85, v85, v11
    v_sub_f32 v86, v86, v11
    v_sub_f32 v87, v87, v11
    v_sub_f32 v88, v88, v11
    v_sub_f32 v89, v89, v11
    v_sub_f32 v90, v90, v11
    v_sub_f32 v91, v91, v11
    v_sub_f32 v16, v16, v11
    v_sub_f32 v17, v17, v11
    v_sub_f32 v18, v18, v11
    v_sub_f32 v19, v19, v11
    v_exp_f32 v8, -v11
    s_mov_b32 s46, 1
    v_max3_f32 v11, v100, v101, v102
    v_max3_f32 v11, v11, v103, v104
    v_max3_f32 v11, v11, v105, v106
    v_max_f32 v11, v11, v107
    v_mov_b32 v10, v11
    s_nop 1
    v_permlane32_swap_b32 v11, v10
    v_max_f32 v11, v11, v10
    v_mov_b32 v10, v11
    s_nop 1
    v_permlane16_swap_b32 v11, v10
    v_max_f32 v11, v11, v10
    v_max_f32 v11, s68, v11
    v_sub_f32 v100, v100, v11
    v_sub_f32 v101, v101, v11
    v_sub_f32 v102, v102, v11
    v_sub_f32 v103, v103, v11
    v_sub_f32 v104, v104, v11
    v_sub_f32 v105, v105, v11
    v_sub_f32 v106, v106, v11
    v_sub_f32 v107, v107, v11
    v_sub_f32 v20, v20, v11
    v_sub_f32 v21, v21, v11
    v_sub_f32 v22, v22, v11
    v_sub_f32 v23, v23, v11
    v_exp_f32 v10, -v11
    s_mov_b32 s46, 1
    s_mov_b32 s66, 0x41000000
    s_mov_b32 s68, 0
    s_setpc_b64 s[6:7]
k1_rare8:
    v_max3_f32 v11, v108, v109, v110
    v_max3_f32 v11, v11, v111, v112
    v_max3_f32 v11, v11, v113, v114
    v_max_f32 v11, v11, v115
    v_mov_b32 v9, v11
    s_nop 1
    v_permlane32_swap_b32 v11, v9
    v_max_f32 v11, v11, v9
    v_mov_b32 v9, v11
    s_nop 1
    v_permlane16_swap_b32 v11, v9
    v_max_f32 v11, v11, v9
    v_max_f32 v11, s69, v11
    v_sub_f32 v108, v108, v11
    v_sub_f32 v109, v109, v11
    v_sub_f32 v110, v110, v11
    v_sub_f32 v111, v111, v11
    v_sub_f32 v112, v112, v11
    v_sub_f32 v113, v113, v11
    v_sub_f32 v114, v114, v11
    v_sub_f32 v115, v115, v11
    v_sub_f32 v24, v24, v11
    v_sub_f32 v25, v25, v11
    v_sub_f32 v26, v26, v11
    v_sub_f32 v27, v27, v11
    s_cmp_lg_u32 s69, 0
    s_cbranch_scc1 k1_first_27
    v_exp_f32 v9, -v11
    s_nop 0
    v_mul_f32 v220, v220, v9
    v_mul_f32 v221, v221, v9
    v_mul_f32 v222, v222, v9
    v_mul_f32 v223, v223, v9
    v_mul_f32 v224, v224, v9
    v_mul_f32 v225, v225, v9
    v_mul_f32 v226, v226, v9
    v_mul_f32 v227, v227, v9
    v_mul_f32 v228, v228, v9
    v_mul_f32 v229, v229, v9
    v_mul_f32 v230, v230, v9
    v_mul_f32 v231, v231, v9
    v_mul_f32 v232, v232, v9
    v_mul_f32 v233, v233, v9
    v_mul_f32 v234, v234, v9
    v_mul_f32 v235, v235, v9
    v_mul_f32 v236, v236, v9
    v_mul_f32 v237, v237, v9
    v_mul_f32 v238, v238, v9
    v_mul_f32 v239, v239, v9
    v_mul_f32 v240, v240, v9
    v_mul_f32 v241, v241, v9
    v_mul_f32 v242, v242, v9
    v_mul_f32 v243, v243, v9
    v_mul_f32 v244, v244, v9
    v_mul_f32 v245, v245, v9
    v_mul_f32 v246, v246, v9
    v_mul_f32 v247, v247, v9
    v_mul_f32 v248, v248, v9
    v_mul_f32 v249, v249, v9
    v_mul_f32 v250, v250, v9
    v_mul_f32 v251, v251, v9
    v_mul_f32 v252, v252, v9
    v_mul_f32 v253, v253, v9
    v_mul_f32 v254, v254, v9
    v_mul_f32 v255, v255, v9
k1_first_27:
    s_mov_b32 s67, 0x41000000
    s_mov_b32 s69, 0
    s_setpc_b64 s[6:7]
k1_early:
    s_setprio 0
    s_lshr_b32 s12, s41, 1
    s_xor_b32 s56, s41, s12
    s_and_b32 s56, s56, 1
    s_lshl_b32 s56, s56, 1
    s_or_b32 s56, s56, s12
    v_and_b32 v36, 7, v0
    v_xor_b32 v36, s56, v36
    v_bfe_u32 v37, v0, 4, 1
    v_lshlrev_b32 v37, 2, v37
    v_xor_b32 v36, v36, v37
    s_and_b32 s12, s45, 1
    s_lshl_b32 s12, s12, 7
    v_lshl_add_u32 v36, v36, 4, s12
    v_lshrrev_b32 v37, 5, v0
    v_lshl_add_u32 v36, v37, 15, v36
    v_bfe_u32 v37, v0, 3, 2
    s_lshl_b32 s12, s41, 2
    v_add_u32 v37, s12, v37
    v_lshl_add_u32 v28, v37, 11, v36
    s_lshl_b32 s55, s41, 12
    v_add_u32 v29, 64512, v28
    v_xor_b32 v30, 0x80, v28
    v_xor_b32 v31, 0x80, v29
    s_lshl_b32 s54, s45, 19
    s_lshr_b32 s12, s45, 1
    s_lshl_b32 s12, s12, 8
    s_add_u32 s24, s18, s12
    s_addc_u32 s25, s19, 0
    s_sub_u32 s26, 8388608, s12
    s_mov_b32 s27, 0x20000
    s_mov_b32 s28, s100
    s_mov_b32 s29, s101
    s_mov_b32 s30, 256
    s_mov_b32 s31, 0x20000
    v_mov_b32 v38, 0
    buffer_load_dword v39, v38, s[28:31], 0 offen sc1
    s_add_u32 m0, s55, 32768
    s_add_u32 s49, s54, 0
    buffer_load_dwordx4 v28, s[24:27], s49 offen offset:0 lds
    buffer_load_dwordx4 v29, s[24:27], s49 offen offset:1024 lds
    s_add_u32 m0, s55, 34816
    s_nop 0
    buffer_load_dwordx4 v30, s[24:27], s49 offen offset:0 lds
    buffer_load_dwordx4 v31, s[24:27], s49 offen offset:1024 lds
    s_add_u32 m0, s55, 49152
    s_add_u32 s49, s54, 131072
    buffer_load_dwordx4 v28, s[24:27], s49 offen offset:0 lds
    buffer_load_dwordx4 v29, s[24:27], s49 offen offset:1024 lds
    s_add_u32 m0, s55, 51200
    s_nop 0
    buffer_load_dwordx4 v30, s[24:27], s49 offen offset:0 lds
    buffer_load_dwordx4 v31, s[24:27], s49 offen offset:1024 lds
    s_add_u32 m0, s55, 65536
    s_add_u32 s49, s54, 262144
    buffer_load_dwordx4 v28, s[24:27], s49 offen offset:0 lds
    buffer_load_dwordx4 v29, s[24:27], s49 offen offset:1024 lds
    s_add_u32 m0, s55, 67584
    s_nop 0
    buffer_load_dwordx4 v30, s[24:27], s49 offen offset:0 lds
    buffer_load_dwordx4 v31, s[24:27], s49 offen offset:1024 lds
    s_lshl_b32 s12, s43, 3
    s_add_u32 s12, s12, s44
    s_lshl_b32 s60, s12, 11
    s_add_u32 s60, s60, 65536
    v_and_b32 v34, 15, v0
    v_lshlrev_b32 v34, 7, v34
    s_setpc_b64 s[6:7]
k1_rescale:
    s_nop 1
    v_mul_f32 v148, v148, v8
    v_mul_f32 v149, v149, v8
    v_mul_f32 v150, v150, v8
    v_mul_f32 v151, v151, v8
    v_mul_f32 v152, v152, v8
    v_mul_f32 v153, v153, v8
    v_mul_f32 v154, v154, v8
    v_mul_f32 v155, v155, v8
    v_mul_f32 v156, v156, v8
    v_mul_f32 v157, v157, v8
    v_mul_f32 v158, v158, v8
    v_mul_f32 v159, v159, v8
    v_mul_f32 v160, v160, v8
    v_mul_f32 v161, v161, v8
    v_mul_f32 v162, v162, v8
    v_mul_f32 v163, v163, v8
    v_mul_f32 v164, v164, v8
    v_mul_f32 v165, v165, v8
    v_mul_f32 v166, v166, v8
    v_mul_f32 v167, v167, v8
    v_mul_f32 v168, v168, v8
    v_mul_f32 v169, v169, v8
    v_mul_f32 v170, v170, v8
    v_mul_f32 v171, v171, v8
    v_mul_f32 v172, v172, v8
    v_mul_f32 v173, v173, v8
    v_mul_f32 v174, v174, v8
    v_mul_f32 v175, v175, v8
    v_mul_f32 v176, v176, v8
    v_mul_f32 v177, v177, v8
    v_mul_f32 v178, v178, v8
    v_mul_f32 v179, v179, v8
    v_mul_f32 v180, v180, v8
    v_mul_f32 v181, v181, v8
    v_mul_f32 v182, v182, v8
    v_mul_f32 v183, v183, v8
    v_mul_f32 v184, v184, v10
    v_mul_f32 v185, v185, v10
    v_mul_f32 v186, v186, v10
    v_mul_f32 v187, v187, v10
    v_mul_f32 v188, v188, v10
    v_mul_f32 v189, v189, v10
    v_mul_f32 v190, v190, v10
    v_mul_f32 v191, v191, v10
    v_mul_f32 v192, v192, v10
    v_mul_f32 v193, v193, v10
    v_mul_f32 v194, v194, v10
    v_mul_f32 v195, v195, v10
    v_mul_f32 v196, v196, v10
    v_mul_f32 v197, v197, v10
    v_mul_f32 v198, v198, v10
    v_mul_f32 v199, v199, v10
    v_mul_f32 v200, v200, v10
    v_mul_f32 v201, v201, v10
    v_mul_f32 v202, v202, v10
    v_mul_f32 v203, v203, v10
    v_mul_f32 v204, v204, v10
    v_mul_f32 v205, v205, v10
    v_mul_f32 v206, v206, v10
    v_mul_f32 v207, v207, v10
    v_mul_f32 v208, v208, v10
    v_mul_f32 v209, v209, v10
    v_mul_f32 v210, v210, v10
    v_mul_f32 v211, v211, v10
    v_mul_f32 v212, v212, v10
    v_mul_f32 v213, v213, v10
    v_mul_f32 v214, v214, v10
    v_mul_f32 v215, v215, v10
    v_mul_f32 v216, v216, v10
    v_mul_f32 v217, v217, v10
    v_mul_f32 v218, v218, v10
    v_mul_f32 v219, v219, v10
    s_mov_b32 s46, 0
    s_setpc_b64 s[6:7]
k1_finH:
    s_setprio 3
    s_cmp_eq_u32 s42, 1
    s_cbranch_scc1 k1_early_29_s
k1_early_29:
    s_waitcnt lgkmcnt(10)
    v_mfma_f32_16x16x32_bf16 v[152:155], v[116:119], v[76:79], v[152:155]
    ds_read_b64_tr_b16 v[140:141], v5 offset:512
    v_mfma_f32_16x16x32_bf16 v[188:191], v[116:119], v[92:95], v[188:191]
    v_max3_f32 v11, v84, v85, v86
    v_max3_f32 v8, v100, v101, v102
    v_max3_f32 v11, v11, v87, v88
    v_max3_f32 v8, v8, v103, v104
    ds_read_b64_tr_b16 v[142:143], v5 offset:1536
    v_mfma_f32_16x16x32_bf16 v[224:227], v[116:119], v[108:111], v[224:227]
    v_max3_f32 v11, v11, v89, v90
    v_max3_f32 v8, v8, v105, v106
    s_waitcnt lgkmcnt(10)
    v_mfma_f32_16x16x32_bf16 v[156:159], v[120:123], v[76:79], v[156:159]
    v_add_u32 v3, s47, v3
    v_add_u32 v5, s47, v5
    ds_read_b64_tr_b16 v[144:145], v6 offset:512
    v_mfma_f32_16x16x32_bf16 v[192:195], v[120:123], v[92:95], v[192:195]
    v_max_f32 v11, v11, v91
    v_max3_f32 v8, v8, v107, v11
    ds_read_b64_tr_b16 v[146:147], v6 offset:1536
    v_mfma_f32_16x16x32_bf16 v[228:231], v[120:123], v[108:111], v[228:231]
    v_cmp_lt_f32 vcc, s66, v8
    s_cbranch_vccnz k1_ok_30_s
k1_ok_30:
    s_waitcnt lgkmcnt(10)
    v_mfma_f32_16x16x32_bf16 v[160:163], v[124:127], v[76:79], v[160:163]
    v_add_u32 v4, s47, v4
    v_add_u32 v6, s47, v6
    ds_read_b64_tr_b16 v[116:117], v3 offset:0
    v_mfma_f32_16x16x32_bf16 v[196:199], v[124:127], v[92:95], v[196:199]
    v_exp_f32 v84, v84
    ds_read_b64_tr_b16 v[118:119], v3 offset:1024
    v_mfma_f32_16x16x32_bf16 v[232:235], v[124:127], v[108:111], v[232:235]
    v_exp_f32 v100, v100
    s_waitcnt lgkmcnt(10)
    v_mfma_f32_16x16x32_bf16 v[164:167], v[128:131], v[76:79], v[164:167]
    v_exp_f32 v85, v85
    ds_read_b64_tr_b16 v[120:121], v4 offset:0
    v_mfma_f32_16x16x32_bf16 v[200:203], v[128:131], v[92:95], v[200:203]
    v_exp_f32 v101, v101
    ds_read_b64_tr_b16 v[122:123], v4 offset:1024
    v_mfma_f32_16x16x32_bf16 v[236:239], v[128:131], v[108:111], v[236:239]
    v_exp_f32 v86, v86
    s_waitcnt lgkmcnt(10)
    v_mfma_f32_16x16x32_bf16 v[168:171], v[132:135], v[76:79], v[168:171]
    v_exp_f32 v102, v102
    ds_read_b64_tr_b16 v[124:125], v5 offset:0
    v_mfma_f32_16x16x32_bf16 v[204:207], v[132:135], v[92:95], v[204:207]
    v_cvt_pk_bf16_f32 v84, v84, v85
    v_cvt_pk_bf16_f32 v100, v100, v101
    v_exp_f32 v87, v87
    ds_read_b64_tr_b16 v[126:127], v5 offset:1024
    v_mfma_f32_16x16x32_bf16 v[240:243], v[132:135], v[108:111], v[240:243]
    v_exp_f32 v103, v103
    s_waitcnt lgkmcnt(10)
    v_mfma_f32_16x16x32_bf16 v[172:175], v[136:139], v[76:79], v[172:175]
    v_exp_f32 v88, v88
    ds_read_b64_tr_b16 v[128:129], v6 offset:0
    v_mfma_f32_16x16x32_bf16 v[208:211], v[136:139], v[92:95], v[208:211]
    v_exp_f32 v104, v104
    ds_read_b64_tr_b16 v[130:131], v6 offset:1024
    v_mfma_f32_16x16x32_bf16 v[244:247], v[136:139], v[108:111], v[244:247]
    v_cvt_pk_bf16_f32 v85, v86, v87
    v_cvt_pk_bf16_f32 v101, v102, v103
    s_waitcnt lgkmcnt(10)
    v_mfma_f32_16x16x32_bf16 v[176:179], v[140:143], v[76:79], v[176:179]
    v_exp_f32 v89, v89
    ds_read_b64_tr_b16 v[132:133], v3 offset:512
    v_mfma_f32_16x16x32_bf16 v[212:215], v[140:143], v[92:95], v[212:215]
    v_exp_f32 v105, v105
    ds_read_b64_tr_b16 v[134:135], v3 offset:1536
    v_mfma_f32_16x16x32_bf16 v[248:251], v[140:143], v[108:111], v[248:251]
    v_exp_f32 v90, v90
    s_waitcnt lgkmcnt(10)
    v_mfma_f32_16x16x32_bf16 v[180:183], v[144:147], v[76:79], v[180:183]
    v_exp_f32 v106, v106
    ds_read_b64_tr_b16 v[136:137], v4 offset:512
    v_mfma_f32_16x16x32_bf16 v[216:219], v[144:147], v[92:95], v[216:219]
    v_cvt_pk_bf16_f32 v86, v88, v89
    v_cvt_pk_bf16_f32 v102, v104, v105
    ds_read_b64_tr_b16 v[138:139], v4 offset:1536
    v_mfma_f32_16x16x32_bf16 v[252:255], v[144:147], v[108:111], v[252:255]
    v_exp_f32 v91, v91
    v_mfma_f32_16x16x32_bf16 v[148:151], v[12:15], v[76:79], v[148:151]
    v_exp_f32 v107, v107
    v_mfma_f32_16x16x32_bf16 v[184:187], v[12:15], v[92:95], v[184:187]
    v_cvt_pk_bf16_f32 v87, v90, v91
    v_cvt_pk_bf16_f32 v103, v106, v107
    v_mfma_f32_16x16x32_bf16 v[220:223], v[12:15], v[108:111], v[220:223]
    s_cmp_lg_u32 s46, 0
    s_cbranch_scc1 k1_nors_31_s
k1_nors_31:
    s_waitcnt lgkmcnt(10)
    v_mfma_f32_16x16x32_bf16 v[152:155], v[116:119], v[84:87], v[152:155]
    ds_read_b64_tr_b16 v[140:141], v5 offset:512
    s_lshl_b32 s5, s42, 15
    s_add_u32 s5, s5, 81920
    s_lshl_b32 s13, s42, 14
    s_lshl_b32 s4, s41, 11
    s_add_u32 s3, s4, s5
    v_lshl_add_u32 v1, v0, 4, s3
    v_mfma_f32_16x16x32_bf16 v[188:191], v[116:119], v[100:103], v[188:191]
    ds_read_b64_tr_b16 v[142:143], v5 offset:1536
    v_add_u32 v2, s13, v1
    s_lshl_b32 s3, s40, 9
    v_lshl_add_u32 v7, v0, 3, s3
    s_waitcnt lgkmcnt(10)
    v_mfma_f32_16x16x32_bf16 v[156:159], v[120:123], v[84:87], v[156:159]
    v_add_u32 v3, s63, v3
    v_add_u32 v5, s63, v5
    ds_read_b64_tr_b16 v[144:145], v6 offset:512
    v_mfma_f32_16x16x32_bf16 v[192:195], v[120:123], v[100:103], v[192:195]
    ds_read_b64_tr_b16 v[146:147], v6 offset:1536
    v_mov_b32 v25, v220
    s_waitcnt lgkmcnt(10)
    v_mfma_f32_16x16x32_bf16 v[160:163], v[124:127], v[84:87], v[160:163]
    v_add_u32 v4, s63, v4
    v_add_u32 v6, s63, v6
    ds_write_b128 v1, v[224:227] offset:0
    v_mfma_f32_16x16x32_bf16 v[196:199], v[124:127], v[100:103], v[196:199]
    ds_write_b128 v1, v[228:231] offset:1024
    s_waitcnt lgkmcnt(10)
    v_mfma_f32_16x16x32_bf16 v[164:167], v[128:131], v[84:87], v[164:167]
    ds_write_b128 v1, v[232:235] offset:8192
    v_mfma_f32_16x16x32_bf16 v[200:203], v[128:131], v[100:103], v[200:203]
    ds_write_b128 v1, v[236:239] offset:9216
    s_waitcnt lgkmcnt(10)
    v_mfma_f32_16x16x32_bf16 v[168:171], v[132:135], v[84:87], v[168:171]
    ds_write_b128 v2, v[240:243] offset:16384
    v_mfma_f32_16x16x32_bf16 v[204:207], v[132:135], v[100:103], v[204:207]
    ds_write_b128 v2, v[244:247] offset:17408
    s_waitcnt lgkmcnt(10)
    v_mfma_f32_16x16x32_bf16 v[172:175], v[136:139], v[84:87], v[172:175]
    ds_write_b128 v2, v[248:251] offset:24576
    v_mfma_f32_16x16x32_bf16 v[208:211], v[136:139], v[100:103], v[208:211]
    ds_write_b128 v2, v[252:255] offset:25600
    s_waitcnt lgkmcnt(10)
    v_mfma_f32_16x16x32_bf16 v[176:179], v[140:143], v[84:87], v[176:179]
    ds_write_b64 v7, v[24:25]
    v_mfma_f32_16x16x32_bf16 v[212:215], v[140:143], v[100:103], v[212:215]
    s_waitcnt lgkmcnt(9)
    v_mfma_f32_16x16x32_bf16 v[180:183], v[144:147], v[84:87], v[180:183]
    v_mfma_f32_16x16x32_bf16 v[216:219], v[144:147], v[100:103], v[216:219]
    v_mfma_f32_16x16x32_bf16 v[148:151], v[12:15], v[84:87], v[148:151]
    v_mfma_f32_16x16x32_bf16 v[184:187], v[12:15], v[100:103], v[184:187]
    s_setprio 0
    s_branch k1_epi
k1_ok_7_s:
    s_call_b64 s[6:7], k1_rare0
    s_branch k1_ok_7
k1_ok_8_s:
    s_call_b64 s[6:7], k1_rare8
    s_branch k1_ok_8
k1_ok_9_s:
    s_call_b64 s[6:7], k1_rare1
    s_branch k1_ok_9
k1_nors_10_s:
    s_call_b64 s[6:7], k1_rescale
    s_branch k1_nors_10
k1_ok_11_s:
    s_call_b64 s[6:7], k1_rare0
    s_branch k1_ok_11
k1_nors_12_s:
    s_call_b64 s[6:7], k1_rescale
    s_branch k1_nors_12
k1_ok_13_s:
    s_call_b64 s[6:7], k1_rare1
    s_branch k1_ok_13
k1_nors_14_s:
    s_call_b64 s[6:7], k1_rescale
    s_branch k1_nors_14
k1_ok_15_s:
    s_call_b64 s[6:7], k1_rare0
    s_branch k1_ok_15
k1_ok_16_s:
    s_call_b64 s[6:7], k1_rare8
    s_branch k1_ok_16
k1_nors_17_s:
    s_call_b64 s[6:7], k1_rescale
    s_branch k1_nors_17
k1_ok_18_s:
    s_call_b64 s[6:7], k1_rare0
    s_branch k1_ok_18
k1_early_29_s:
    s_call_b64 s[6:7], k1_early
    s_branch k1_early_29
k1_ok_30_s:
    s_call_b64 s[6:7], k1_rare1
    s_branch k1_ok_30
k1_nors_31_s:
    s_call_b64 s[6:7], k1_rescale
    s_branch k1_nors_31
k1_early_32_s:
    s_call_b64 s[6:7], k1_early
    s_branch k1_early_32
k1_ok_33_s:
    s_call_b64 s[6:7], k1_rare1
    s_branch k1_ok_33
k1_nors_34_s:
    s_call_b64 s[6:7], k1_rescale
    s_branch k1_nors_34
k1_finL:
    s_setprio 3
    s_cmp_eq_u32 s42, 1
    s_cbranch_scc1 k1_early_32_s
k1_early_32:
    s_waitcnt lgkmcnt(10)
    v_mfma_f32_16x16x32_bf16 v[152:155], v[116:119], v[76:79], v[152:155]
    ds_read_b64_tr_b16 v[140:141], v5 offset:512
    v_mfma_f32_16x16x32_bf16 v[188:191], v[116:119], v[92:95], v[188:191]
    v_max3_f32 v11, v84, v85, v86
    v_max3_f32 v8, v100, v101, v102
    v_max3_f32 v11, v11, v87, v88
    v_max3_f32 v8, v8, v103, v104
    ds_read_b64_tr_b16 v[142:143], v5 offset:1536
    s_waitcnt lgkmcnt(10)
    v_mfma_f32_16x16x32_bf16 v[156:159], v[120:123], v[76:79], v[156:159]
    v_add_u32 v3, s47, v3
    v_add_u32 v5, s47, v5
    v_max3_f32 v11, v11, v89, v90
    v_max3_f32 v8, v8, v105, v106
    ds_read_b64_tr_b16 v[144:145], v6 offset:512
    v_mfma_f32_16x16x32_bf16 v[192:195], v[120:123], v[92:95], v[192:195]
    v_max_f32 v11, v11, v91
    v_max3_f32 v8, v8, v107, v11
    v_cmp_lt_f32 vcc, s66, v8
    s_cbranch_vccnz k1_ok_33_s
k1_ok_33:
    ds_read_b64_tr_b16 v[146:147], v6 offset:1536
    s_waitcnt lgkmcnt(10)
    v_mfma_f32_16x16x32_bf16 v[160:163], v[124:127], v[76:79], v[160:163]
    v_add_u32 v4, s47, v4
    v_add_u32 v6, s47, v6
    ds_read_b64_tr_b16 v[116:117], v3 offset:0
    v_mfma_f32_16x16x32_bf16 v[196:199], v[124:127], v[92:95], v[196:199]
    v_exp_f32 v84, v84
    v_exp_f32 v100, v100
    ds_read_b64_tr_b16 v[118:119], v3 offset:1024
    s_waitcnt lgkmcnt(10)
    v_mfma_f32_16x16x32_bf16 v[164:167], v[128:131], v[76:79], v[164:167]
    v_exp_f32 v85, v85
    v_exp_f32 v101, v101
    ds_read_b64_tr_b16 v[120:121], v4 offset:0
    v_mfma_f32_16x16x32_bf16 v[200:203], v[128:131], v[92:95], v[200:203]
    v_exp_f32 v86, v86
    ds_read_b64_tr_b16 v[122:123], v4 offset:1024
    s_waitcnt lgkmcnt(10)
    v_mfma_f32_16x16x32_bf16 v[168:171], v[132:135], v[76:79], v[168:171]
    v_exp_f32 v102, v102
    v_cvt_pk_bf16_f32 v84, v84, v85
    v_cvt_pk_bf16_f32 v100, v100, v101
    ds_read_b64_tr_b16 v[124:125], v5 offset:0
    v_mfma_f32_16x16x32_bf16 v[204:207], v[132:135], v[92:95], v[204:207]
    v_exp_f32 v87, v87
    v_exp_f32 v103, v103
    ds_read_b64_tr_b16 v[126:127], v5 offset:1024
    s_waitcnt lgkmcnt(10)
    v_mfma_f32_16x16x32_bf16 v[172:175], v[136:139], v[76:79], v[172:175]
    v_exp_f32 v88, v88
    ds_read_b64_tr_b16 v[128:129], v6 offset:0
    v_mfma_f32_16x16x32_bf16 v[208:211], v[136:139], v[92:95], v[208:211]
    v_exp_f32 v104, v104
    v_cvt_pk_bf16_f32 v85, v86, v87
    v_cvt_pk_bf16_f32 v101, v102, v103
    ds_read_b64_tr_b16 v[130:131], v6 offset:1024
    s_waitcnt lgkmcnt(10)
    v_mfma_f32_16x16x32_bf16 v[176:179], v[140:143], v[76:79], v[176:179]
    v_exp_f32 v89, v89
    v_exp_f32 v105, v105
    ds_read_b64_tr_b16 v[132:133], v3 offset:512
    v_mfma_f32_16x16x32_bf16 v[212:215], v[140:143], v[92:95], v[212:215]
    v_exp_f32 v90, v90
    ds_read_b64_tr_b16 v[134:135], v3 offset:1536
    s_waitcnt lgkmcnt(10)
    v_mfma_f32_16x16x32_bf16 v[180:183], v[144:147], v[76:79], v[180:183]
    v_exp_f32 v106, v106
    v_cvt_pk_bf16_f32 v86, v88, v89
    v_cvt_pk_bf16_f32 v102, v104, v105
    ds_read_b64_tr_b16 v[136:137], v4 offset:512
    v_mfma_f32_16x16x32_bf16 v[216:219], v[144:147], v[92:95], v[216:219]
    v_exp_f32 v91, v91
    v_exp_f32 v107, v107
    ds_read_b64_tr_b16 v[138:139], v4 offset:1536
    v_mfma_f32_16x16x32_bf16 v[148:151], v[12:15], v[76:79], v[148:151]
    v_cvt_pk_bf16_f32 v87, v90, v91
    v_cvt_pk_bf16_f32 v103, v106, v107
    v_mfma_f32_16x16x32_bf16 v[184:187], v[12:15], v[92:95], v[184:187]
    s_cmp_lg_u32 s46, 0
    s_cbranch_scc1 k1_nors_34_s
k1_nors_34:
    s_waitcnt lgkmcnt(10)
    v_mfma_f32_16x16x32_bf16 v[152:155], v[116:119], v[84:87], v[152:155]
    ds_read_b64_tr_b16 v[140:141], v5 offset:512
    s_lshl_b32 s5, s42, 15
    s_add_u32 s5, s5, 81920
    s_lshl_b32 s13, s42, 14
    s_lshl_b32 s4, s41, 11
    s_add_u32 s3, s4, s5
    v_lshl_add_u32 v1, v0, 4, s3
    v_mfma_f32_16x16x32_bf16 v[188:191], v[116:119], v[100:103], v[188:191]
    ds_read_b64_tr_b16 v[142:143], v5 offset:1536
    v_add_u32 v2, s13, v1
    s_lshl_b32 s3, s40, 9
    v_lshl_add_u32 v7, v0, 3, s3
    s_waitcnt lgkmcnt(10)
    v_mfma_f32_16x16x32_bf16 v[156:159], v[120:123], v[84:87], v[156:159]
    v_add_u32 v3, s63, v3
    v_add_u32 v5, s63, v5
    ds_read_b64_tr_b16 v[144:145], v6 offset:512
    v_mfma_f32_16x16x32_bf16 v[192:195], v[120:123], v[100:103], v[192:195]
    ds_read_b64_tr_b16 v[146:147], v6 offset:1536
    v_mov_b32 v25, v220
    s_waitcnt lgkmcnt(10)
    v_mfma_f32_16x16x32_bf16 v[160:163], v[124:127], v[84:87], v[160:163]
    v_add_u32 v4, s63, v4
    v_add_u32 v6, s63, v6
    ds_write_b128 v1, v[224:227] offset:0
    v_mfma_f32_16x16x32_bf16 v[196:199], v[124:127], v[100:103], v[196:199]
    ds_write_b128 v1, v[228:231] offset:1024
    s_waitcnt lgkmcnt(10)
    v_mfma_f32_16x16x32_bf16 v[164:167], v[128:131], v[84:87], v[164:167]
    ds_write_b128 v1, v[232:235] offset:8192
    v_mfma_f32_16x16x32_bf16 v[200:203], v[128:131], v[100:103], v[200:203]
    ds_write_b128 v1, v[236:239] offset:9216
    s_waitcnt lgkmcnt(10)
    v_mfma_f32_16x16x32_bf16 v[168:171], v[132:135], v[84:87], v[168:171]
    ds_write_b128 v2, v[240:243] offset:16384
    v_mfma_f32_16x16x32_bf16 v[204:207], v[132:135], v[100:103], v[204:207]
    ds_write_b128 v2, v[244:247] offset:17408
    s_waitcnt lgkmcnt(10)
    v_mfma_f32_16x16x32_bf16 v[172:175], v[136:139], v[84:87], v[172:175]
    ds_write_b128 v2, v[248:251] offset:24576
    v_mfma_f32_16x16x32_bf16 v[208:211], v[136:139], v[100:103], v[208:211]
    ds_write_b128 v2, v[252:255] offset:25600
    s_waitcnt lgkmcnt(10)
    v_mfma_f32_16x16x32_bf16 v[176:179], v[140:143], v[84:87], v[176:179]
    ds_write_b64 v7, v[24:25]
    v_mfma_f32_16x16x32_bf16 v[212:215], v[140:143], v[100:103], v[212:215]
    s_waitcnt lgkmcnt(9)
    v_mfma_f32_16x16x32_bf16 v[180:183], v[144:147], v[84:87], v[180:183]
    v_mfma_f32_16x16x32_bf16 v[216:219], v[144:147], v[100:103], v[216:219]
    v_mfma_f32_16x16x32_bf16 v[148:151], v[12:15], v[84:87], v[148:151]
    v_mfma_f32_16x16x32_bf16 v[184:187], v[12:15], v[100:103], v[184:187]
    s_setprio 0
k1_epi:
    v_lshlrev_b32 v3, 4, v0
    s_lshl_b32 s3, s42, 11
    v_lshl_add_u32 v5, v0, 3, s3
    s_lshl_b32 s6, s41, 13
    s_add_u32 s6, s6, s5
    s_cmp_ge_u32 s41, 2
    s_cselect_b32 s13, s13, 0
    s_add_u32 s6, s6, s13
    v_add_u32 v4, s6, v3
    v_mov_b32 v2, v4
    s_add_u32 s36, s16, 50331648
    s_addc_u32 s37, s17, 0
    s_mov_b32 s38, 98304
    s_mov_b32 s39, 0x20000
    s_cmp_eq_u32 s42, 0
    s_cbranch_scc1 k1_nosnap
    s_mov_b32 s61, 0
    s_movk_i32 s12, 0x100
    s_waitcnt vmcnt(12)
k2_allin:
    v_cmp_le_u32 vcc, s12, v39
    s_cbranch_vccnz k2_allok
    buffer_load_dword v39, v38, s[28:31], 0 offen sc1
    s_add_u32 s61, s61, 1
    s_waitcnt vmcnt(0)
    s_cmp_lt_u32 s61, 100000
    s_cbranch_scc1 k2_allin
k2_allok:
    buffer_load_dword v35, v34, s[36:39], s60 offen sc1
k1_nosnap:
    s_load_dwordx2 s[10:11], s[0:1], 80
    s_lshl_b32 s3, s43, 3
    s_add_u32 s3, s3, s44
    s_mul_i32 s3, s3, 1179648
    s_mul_i32 s6, s45, 73728
    s_add_u32 s3, s3, s6
    s_add_u32 s32, s16, s3
    s_addc_u32 s33, s17, 0
    s_mov_b32 s34, 73728
    s_mov_b32 s35, 0x20000
    s_mul_i32 s3, s42, 36864
    v_add_u32 v6, s4, v3
    v_rcp_f32 v148, v148
    v_rcp_f32 v149, v149
    v_rcp_f32 v184, v184
    v_rcp_f32 v185, v185
    s_add_u32 s6, s3, 81920
    v_add_u32 v4, s6, v6
    s_mov_b32 s6, s3
    v_pk_mul_f32 v[152:153], v[152:153], v[148:149]
    v_pk_mul_f32 v[154:155], v[154:155], v[148:149]
    v_pk_mul_f32 v[156:157], v[156:157], v[148:149]
    v_pk_mul_f32 v[158:159], v[158:159], v[148:149]
    v_cvt_pk_bf16_f32 v152, v152, v153
    v_cvt_pk_bf16_f32 v153, v154, v155
    v_cvt_pk_bf16_f32 v154, v156, v157
    v_cvt_pk_bf16_f32 v155, v158, v159
    buffer_store_dwordx4 v[152:155], v6, s[32:35], s6 offen offset:0 sc1
    v_pk_mul_f32 v[188:189], v[188:189], v[184:185]
    v_pk_mul_f32 v[190:191], v[190:191], v[184:185]
    v_pk_mul_f32 v[192:193], v[192:193], v[184:185]
    v_pk_mul_f32 v[194:195], v[194:195], v[184:185]
    v_cvt_pk_bf16_f32 v188, v188, v189
    v_cvt_pk_bf16_f32 v189, v190, v191
    v_cvt_pk_bf16_f32 v190, v192, v193
    v_cvt_pk_bf16_f32 v191, v194, v195
    buffer_store_dwordx4 v[188:191], v6, s[32:35], s6 offen offset:1024 sc1
    s_add_u32 s6, s6, 9216
    v_pk_mul_f32 v[160:161], v[160:161], v[148:149]
    v_pk_mul_f32 v[162:163], v[162:163], v[148:149]
    v_pk_mul_f32 v[164:165], v[164:165], v[148:149]
    v_pk_mul_f32 v[166:167], v[166:167], v[148:149]
    v_cvt_pk_bf16_f32 v160, v160, v161
    v_cvt_pk_bf16_f32 v161, v162, v163
    v_cvt_pk_bf16_f32 v162, v164, v165
    v_cvt_pk_bf16_f32 v163, v166, v167
    buffer_store_dwordx4 v[160:163], v6, s[32:35], s6 offen offset:0 sc1
    v_pk_mul_f32 v[196:197], v[196:197], v[184:185]
    v_pk_mul_f32 v[198:199], v[198:199], v[184:185]
    v_pk_mul_f32 v[200:201], v[200:201], v[184:185]
    v_pk_mul_f32 v[202:203], v[202:203], v[184:185]
    v_cvt_pk_bf16_f32 v196, v196, v197
    v_cvt_pk_bf16_f32 v197, v198, v199
    v_cvt_pk_bf16_f32 v198, v200, v201
    v_cvt_pk_bf16_f32 v199, v202, v203
    buffer_store_dwordx4 v[196:199], v6, s[32:35], s6 offen offset:1024 sc1
    s_add_u32 s6, s6, 9216
    v_pk_mul_f32 v[168:169], v[168:169], v[148:149]
    v_pk_mul_f32 v[170:171], v[170:171], v[148:149]
    v_pk_mul_f32 v[172:173], v[172:173], v[148:149]
    v_pk_mul_f32 v[174:175], v[174:175], v[148:149]
    v_cvt_pk_bf16_f32 v168, v168, v169
    v_cvt_pk_bf16_f32 v169, v170, v171
    v_cvt_pk_bf16_f32 v170, v172, v173
    v_cvt_pk_bf16_f32 v171, v174, v175
    buffer_store_dwordx4 v[168:171], v6, s[32:35], s6 offen offset:0 sc1
    v_pk_mul_f32 v[204:205], v[204:205], v[184:185]
    v_pk_mul_f32 v[206:207], v[206:207], v[184:185]
    v_pk_mul_f32 v[208:209], v[208:209], v[184:185]
    v_pk_mul_f32 v[210:211], v[210:211], v[184:185]
    v_cvt_pk_bf16_f32 v204, v204, v205
    v_cvt_pk_bf16_f32 v205, v206, v207
    v_cvt_pk_bf16_f32 v206, v208, v209
    v_cvt_pk_bf16_f32 v207, v210, v211
    buffer_store_dwordx4 v[204:207], v6, s[32:35], s6 offen offset:1024 sc1
    s_add_u32 s6, s6, 9216
    s_cmp_lg_u32 s42, 0
    s_cbranch_scc1 k1_nocs
    s_and_b32 s58, s41, 1
    s_lshr_b32 s57, s41, 1
    v_lshrrev_b32 v45, 4, v0
    v_lshrrev_b32 v47, 1, v45
    v_xor_b32 v46, v45, v47
    v_and_b32 v46, 1, v46
    v_lshl_or_b32 v46, v46, 1, v47
    v_bfe_u32 v47, v0, 1, 1
    v_xor_b32 v46, v46, v47
    v_lshlrev_b32 v46, 4, v46
    v_lshl_add_u32 v46, v45, 12, v46
    v_bfe_u32 v47, v0, 2, 2
    v_lshl_add_u32 v46, v47, 7, v46
    v_bfe_u32 v47, v0, 3, 1
    v_xor_b32 v47, s58, v47
    v_lshl_add_u32 v46, v47, 6, v46
    v_and_b32 v47, 1, v0
    v_lshl_add_u32 v46, v47, 3, v46
    s_lshl_b32 s12, s57, 11
    s_add_u32 s12, s12, 16384
    v_add_u32 v40, s12, v46
    v_xor_b32 v41, 32, v40
    v_lshlrev_b32 v44, 4, v0
    v_add_u32 v42, 81920, v44
    v_add_u32 v43, 91136, v44
    v_mov_b64 v[48:49], 0
    v_mov_b64 v[50:51], 0
    v_mov_b64 v[52:53], 0
    v_mov_b64 v[54:55], 0
    v_mov_b64 v[56:57], 0
    v_mov_b64 v[58:59], 0
    v_mov_b64 v[60:61], 0
    v_mov_b64 v[62:63], 0
    v_mov_b64 v[64:65], 0
    v_mov_b64 v[66:67], 0
    v_mov_b64 v[68:69], 0
    v_mov_b64 v[70:71], 0
    v_mov_b64 v[116:117], 0
    v_mov_b64 v[118:119], 0
    v_mov_b64 v[120:121], 0
    v_mov_b64 v[122:123], 0
    v_mov_b64 v[124:125], 0
    v_mov_b64 v[126:127], 0
    v_mov_b64 v[128:129], 0
    v_mov_b64 v[130:131], 0
    v_mov_b64 v[132:133], 0
    v_mov_b64 v[134:135], 0
    v_mov_b64 v[136:137], 0
    v_mov_b64 v[138:139], 0
    v_mov_b64 v[140:141], 0
    v_mov_b64 v[142:143], 0
    v_mov_b64 v[144:145], 0
    v_mov_b64 v[146:147], 0
    v_mov_b64 v[220:221], 0
    v_mov_b64 v[222:223], 0
    v_mov_b64 v[224:225], 0
    v_mov_b64 v[226:227], 0
    v_mov_b64 v[228:229], 0
    v_mov_b64 v[230:231], 0
    v_mov_b64 v[232:233], 0
    v_mov_b64 v[234:235], 0
    s_add_u32 s20, s16, 33554432
    s_addc_u32 s21, s17, 0
    s_mov_b32 s22, 9437184
    s_mov_b32 s23, 0x20000
    s_cmp_eq_u32 s57, 0
    s_cselect_b32 s12, 1, 0
    s_cselect_b32 s61, 9, 7
    s_xor_b32 s12, s2, s12
    s_lshl_b32 s12, s12, 1
    s_add_u32 s12, s12, s58
    s_lshl_b32 s53, s12, 7
    s_mul_i32 s50, s12, 18432
    v_mov_b32 v46, 0
    s_mov_b32 s51, 0
k1_nocs:
    s_waitcnt lgkmcnt(0)
    s_barrier
    ds_read_b64 v[108:109], v5 offset:0
    ds_read_b64 v[110:111], v5 offset:512
    ds_read_b64 v[112:113], v5 offset:1024
    ds_read_b64 v[114:115], v5 offset:1536
    ds_read_b128 v[76:79], v2 offset:0
    ds_read_b128 v[80:83], v2 offset:1024
    ds_read_b128 v[84:87], v2 offset:2048
    ds_read_b128 v[88:91], v2 offset:3072
    ds_read_b128 v[92:95], v2 offset:4096
    ds_read_b128 v[96:99], v2 offset:5120
    ds_read_b128 v[100:103], v2 offset:6144
    ds_read_b128 v[104:107], v2 offset:7168
    v_pk_mul_f32 v[176:177], v[176:177], v[148:149]
    v_pk_mul_f32 v[178:179], v[178:179], v[148:149]
    v_pk_mul_f32 v[180:181], v[180:181], v[148:149]
    v_pk_mul_f32 v[182:183], v[182:183], v[148:149]
    v_cvt_pk_bf16_f32 v176, v176, v177
    v_cvt_pk_bf16_f32 v177, v178, v179
    v_cvt_pk_bf16_f32 v178, v180, v181
    v_cvt_pk_bf16_f32 v179, v182, v183
    buffer_store_dwordx4 v[176:179], v6, s[32:35], s6 offen offset:0 sc1
    v_pk_mul_f32 v[212:213], v[212:213], v[184:185]
    v_pk_mul_f32 v[214:215], v[214:215], v[184:185]
    v_pk_mul_f32 v[216:217], v[216:217], v[184:185]
    v_pk_mul_f32 v[218:219], v[218:219], v[184:185]
    v_cvt_pk_bf16_f32 v212, v212, v213
    v_cvt_pk_bf16_f32 v213, v214, v215
    v_cvt_pk_bf16_f32 v214, v216, v217
    v_cvt_pk_bf16_f32 v215, v218, v219
    buffer_store_dwordx4 v[212:215], v6, s[32:35], s6 offen offset:1024 sc1
    s_waitcnt lgkmcnt(0)
    s_barrier
    ds_write_b128 v4, v[152:155] offset:0
    ds_write_b128 v4, v[188:191] offset:1024
    ds_write_b128 v4, v[160:163] offset:9216
    ds_write_b128 v4, v[196:199] offset:10240
    ds_write_b128 v4, v[168:171] offset:18432
    ds_write_b128 v4, v[204:207] offset:19456
    ds_write_b128 v4, v[176:179] offset:27648
    ds_write_b128 v4, v[212:215] offset:28672
    s_and_b32 s64, s45, 1
    s_lshr_b32 s67, s45, 1
    v_lshlrev_b32 v44, 4, v0
    s_mul_i32 s6, s41, 9216
    s_add_u32 s6, s6, s3
    v_add_u32 v6, 8192, v3
    v_min3_f32 v3, v108, v110, v112
    v_min_f32 v3, v3, v114
    v_sub_f32 v108, v3, v108
    v_sub_f32 v110, v3, v110
    v_sub_f32 v112, v3, v112
    v_sub_f32 v114, v3, v114
    v_exp_f32 v108, v108
    v_exp_f32 v110, v110
    v_exp_f32 v112, v112
    v_exp_f32 v114, v114
    v_mul_f32 v3, v109, v108
    v_fmac_f32 v3, v111, v110
    v_fmac_f32 v3, v113, v112
    v_fmac_f32 v3, v115, v114
    v_rcp_f32 v8, v3
    v_rcp_f32 v9, v3
    v_mul_f32 v76, v76, v108
    v_mul_f32 v77, v77, v108
    v_mul_f32 v78, v78, v108
    v_mul_f32 v79, v79, v108
    v_mul_f32 v80, v80, v108
    v_mul_f32 v81, v81, v108
    v_mul_f32 v82, v82, v108
    v_mul_f32 v83, v83, v108
    v_fmac_f32 v76, v84, v110
    v_fmac_f32 v77, v85, v110
    v_fmac_f32 v78, v86, v110
    v_fmac_f32 v79, v87, v110
    v_fmac_f32 v80, v88, v110
    v_fmac_f32 v81, v89, v110
    v_fmac_f32 v82, v90, v110
    v_fmac_f32 v83, v91, v110
    v_fmac_f32 v76, v92, v112
    v_fmac_f32 v77, v93, v112
    v_fmac_f32 v78, v94, v112
    v_fmac_f32 v79, v95, v112
    v_fmac_f32 v80, v96, v112
    v_fmac_f32 v81, v97, v112
    v_fmac_f32 v82, v98, v112
    v_fmac_f32 v83, v99, v112
    v_fmac_f32 v76, v100, v114
    v_fmac_f32 v77, v101, v114
    v_fmac_f32 v78, v102, v114
    v_fmac_f32 v79, v103, v114
    v_fmac_f32 v80, v104, v114
    v_fmac_f32 v81, v105, v114
    v_fmac_f32 v82, v106, v114
    v_fmac_f32 v83, v107, v114
    v_pk_mul_f32 v[76:77], v[76:77], v[8:9]
    v_pk_mul_f32 v[78:79], v[78:79], v[8:9]
    v_pk_mul_f32 v[80:81], v[80:81], v[8:9]
    v_pk_mul_f32 v[82:83], v[82:83], v[8:9]
    v_cvt_pk_bf16_f32 v76, v76, v77
    v_cvt_pk_bf16_f32 v77, v78, v79
    v_cvt_pk_bf16_f32 v78, v80, v81
    v_cvt_pk_bf16_f32 v79, v82, v83
    buffer_store_dwordx4 v[76:79], v6, s[32:35], s6 offen offset:0 sc1
    s_add_u32 s6, s6, 81920
    v_add_u32 v6, s6, v6
    ds_write_b128 v6, v[76:79]
    s_cmp_eq_u32 s42, 0
    s_cbranch_scc1 k2_comp
    s_add_u32 m0, s55, 16384
    s_add_u32 s49, s54, 393216
    buffer_load_dwordx4 v28, s[24:27], s49 offen offset:0 lds
    buffer_load_dwordx4 v29, s[24:27], s49 offen offset:1024 lds
    s_add_u32 m0, s55, 18432
    s_nop 0
    buffer_load_dwordx4 v30, s[24:27], s49 offen offset:0 lds
    buffer_load_dwordx4 v31, s[24:27], s49 offen offset:1024 lds
    s_waitcnt vmcnt(13) lgkmcnt(0)
    s_barrier
    s_lshr_b32 s12, s45, 2
    s_add_u32 s65, s44, s12
    s_and_b32 s65, s65, 3
    v_add_u32 v32, s55, v44
    s_lshl_b32 s48, s41, 10
    s_add_u32 s48, s48, 16384
    v_add_u32 v33, s48, v44
    s_add_u32 s12, s65, 0
    s_and_b32 s12, s12, 3
    s_lshl_b32 s68, s12, 17
    s_mul_i32 s72, s12, 18432
    s_add_u32 s12, s65, 1
    s_and_b32 s12, s12, 3
    s_lshl_b32 s69, s12, 17
    s_mul_i32 s73, s12, 18432
    s_add_u32 s12, s65, 2
    s_and_b32 s12, s12, 3
    s_lshl_b32 s70, s12, 17
    s_mul_i32 s74, s12, 18432
    s_add_u32 s12, s65, 3
    s_and_b32 s12, s12, 3
    s_lshl_b32 s71, s12, 17
    s_mul_i32 s75, s12, 18432
    s_mov_b32 s62, -1
    s_lshl_b32 s12, s43, 3
    s_add_u32 s12, s12, s44
    s_mul_i32 s12, s12, 1179648
    s_add_u32 s20, s16, s12
    s_addc_u32 s21, s17, 0
    s_mov_b32 s22, 1179648
    s_mov_b32 s23, 0x20000
    s_lshl_b32 s4, s45, 7
    s_add_u32 s4, s4, s60
    v_mov_b32 v39, 1
    s_lshl_b32 s5, s41, 4
    s_add_u32 s5, s5, 1
    s_mov_b32 s52, 1
    s_add_u32 s62, s62, 1
    s_cmp_eq_u32 s62, s67
    s_addc_u32 s62, s62, 0
    s_lshl_b32 s66, s62, 1
    s_add_u32 s66, s66, s64
    s_lshl_b32 s54, s66, 19
    s_mul_i32 s59, s66, 73728
    s_barrier
    v_cmp_eq_u32 vcc, 1, v35
    s_nop 0
    s_bitcmp1_b32 vcc_lo, s66
    s_cbranch_scc1 k2_fast
    s_add_u32 m0, s55, 32768
    s_add_u32 s49, s54, s68
    buffer_load_dwordx4 v28, s[24:27], s49 offen offset:0 lds
    buffer_load_dwordx4 v29, s[24:27], s49 offen offset:1024 lds
    s_add_u32 m0, s55, 34816
    s_nop 0
    buffer_load_dwordx4 v30, s[24:27], s49 offen offset:0 lds
    buffer_load_dwordx4 v31, s[24:27], s49 offen offset:1024 lds
    s_barrier
    s_add_u32 m0, s55, 49152
    s_add_u32 s49, s54, s69
    buffer_load_dwordx4 v28, s[24:27], s49 offen offset:0 lds
    buffer_load_dwordx4 v29, s[24:27], s49 offen offset:1024 lds
    s_add_u32 m0, s55, 51200
    s_nop 0
    buffer_load_dwordx4 v30, s[24:27], s49 offen offset:0 lds
    buffer_load_dwordx4 v31, s[24:27], s49 offen offset:1024 lds
    buffer_load_dword v35, v34, s[36:39], s60 offen sc1
    s_waitcnt vmcnt(9)
    s_barrier
    s_cmp_lg_u32 s41, 0
    s_cbranch_scc1 k2_nopub_35
    s_mov_b64 exec, 1
    buffer_store_dword v39, v38, s[36:39], s4 offen sc1
    s_mov_b64 exec, -1
k2_nopub_35:
    s_add_u32 m0, s55, 65536
    s_add_u32 s49, s54, s70
    buffer_load_dwordx4 v28, s[24:27], s49 offen offset:0 lds
    buffer_load_dwordx4 v29, s[24:27], s49 offen offset:1024 lds
    s_add_u32 m0, s55, 67584
    s_nop 0
    buffer_load_dwordx4 v30, s[24:27], s49 offen offset:0 lds
    buffer_load_dwordx4 v31, s[24:27], s49 offen offset:1024 lds
    s_waitcnt vmcnt(5)
    s_mov_b32 s61, 0
k2_chk_36:
    v_cmp_eq_u32 vcc, 1, v35
    s_nop 0
    s_bitcmp1_b32 vcc_lo, s66
    s_cbranch_scc1 k2_go_37
    buffer_load_dword v35, v34, s[36:39], s60 offen sc1
    s_add_u32 s61, s61, 1
    s_waitcnt vmcnt(0)
    s_cmp_lt_u32 s61, 100000
    s_cbranch_scc1 k2_chk_36
k2_go_37:
    s_add_u32 m0, s55, 81920
    s_add_u32 s50, s59, s72
    buffer_load_dwordx4 v32, s[20:23], s50 offen offset:0 sc1 lds
    buffer_load_dwordx4 v32, s[20:23], s50 offen offset:1024 sc1 lds
    buffer_load_dwordx4 v32, s[20:23], s50 offen offset:2048 sc1 lds
    buffer_load_dwordx4 v32, s[20:23], s50 offen offset:3072 sc1 lds
    s_add_u32 m0, s48, 81920
    s_cmp_ge_u32 s41, 2
    s_cbranch_scc1 k2_skipx_38
    buffer_load_dwordx4 v33, s[20:23], s50 offen sc1 lds
k2_skipx_38:
    s_add_u32 m0, s55, 100352
    s_add_u32 s50, s59, s73
    buffer_load_dwordx4 v32, s[20:23], s50 offen offset:0 sc1 lds
    buffer_load_dwordx4 v32, s[20:23], s50 offen offset:1024 sc1 lds
    buffer_load_dwordx4 v32, s[20:23], s50 offen offset:2048 sc1 lds
    buffer_load_dwordx4 v32, s[20:23], s50 offen offset:3072 sc1 lds
    s_add_u32 m0, s48, 100352
    s_cmp_ge_u32 s41, 2
    s_cbranch_scc1 k2_skipx_39
    buffer_load_dwordx4 v33, s[20:23], s50 offen sc1 lds
k2_skipx_39:
    s_add_u32 m0, s55, 118784
    s_add_u32 s50, s59, s74
    buffer_load_dwordx4 v32, s[20:23], s50 offen offset:0 sc1 lds
    buffer_load_dwordx4 v32, s[20:23], s50 offen offset:1024 sc1 lds
    buffer_load_dwordx4 v32, s[20:23], s50 offen offset:2048 sc1 lds
    buffer_load_dwordx4 v32, s[20:23], s50 offen offset:3072 sc1 lds
    s_add_u32 m0, s48, 118784
    s_cmp_ge_u32 s41, 2
    s_cbranch_scc1 k2_skipx_40
    buffer_load_dwordx4 v33, s[20:23], s50 offen sc1 lds
k2_skipx_40:
    s_waitcnt vmcnt(8)
    s_barrier
    buffer_load_dword v35, v34, s[36:39], s60 offen sc1
    s_add_u32 m0, s55, 16384
    s_add_u32 s49, s54, s71
    buffer_load_dwordx4 v28, s[24:27], s49 offen offset:0 lds
    buffer_load_dwordx4 v29, s[24:27], s49 offen offset:1024 lds
    s_add_u32 m0, s55, 18432
    s_nop 0
    buffer_load_dwordx4 v30, s[24:27], s49 offen offset:0 lds
    buffer_load_dwordx4 v31, s[24:27], s49 offen offset:1024 lds
    s_add_u32 m0, s55, 137216
    s_add_u32 s50, s59, s75
    buffer_load_dwordx4 v32, s[20:23], s50 offen offset:0 sc1 lds
    buffer_load_dwordx4 v32, s[20:23], s50 offen offset:1024 sc1 lds
    buffer_load_dwordx4 v32, s[20:23], s50 offen offset:2048 sc1 lds
    buffer_load_dwordx4 v32, s[20:23], s50 offen offset:3072 sc1 lds
    s_add_u32 m0, s48, 137216
    s_cmp_ge_u32 s41, 2
    s_cbranch_scc1 k2_skipx_41
    buffer_load_dwordx4 v33, s[20:23], s50 offen sc1 lds
k2_skipx_41:
    s_mov_b32 s52, 2
    s_waitcnt vmcnt(12)
k2_lloop:
    s_add_u32 s62, s62, 1
    s_cmp_eq_u32 s62, s67
    s_addc_u32 s62, s62, 0
    s_lshl_b32 s66, s62, 1
    s_add_u32 s66, s66, s64
    s_lshl_b32 s54, s66, 19
    s_mul_i32 s59, s66, 73728
    s_waitcnt vmcnt(16)
    s_barrier
k2_fast:
    s_add_u32 m0, s55, 32768
    s_add_u32 s49, s54, s68
    buffer_load_dwordx4 v28, s[24:27], s49 offen offset:0 lds
    buffer_load_dwordx4 v29, s[24:27], s49 offen offset:1024 lds
    s_add_u32 m0, s55, 34816
    s_nop 0
    buffer_load_dwordx4 v30, s[24:27], s49 offen offset:0 lds
    buffer_load_dwordx4 v31, s[24:27], s49 offen offset:1024 lds
    s_mov_b32 s61, 0
k2_chk_42:
    v_cmp_eq_u32 vcc, 1, v35
    s_nop 0
    s_bitcmp1_b32 vcc_lo, s66
    s_cbranch_scc1 k2_go_43
    buffer_load_dword v35, v34, s[36:39], s60 offen sc1
    s_add_u32 s61, s61, 1
    s_waitcnt vmcnt(0)
    s_cmp_lt_u32 s61, 100000
    s_cbranch_scc1 k2_chk_42
k2_go_43:
    s_add_u32 m0, s55, 81920
    s_add_u32 s50, s59, s72
    buffer_load_dwordx4 v32, s[20:23], s50 offen offset:0 sc1 lds
    buffer_load_dwordx4 v32, s[20:23], s50 offen offset:1024 sc1 lds
    buffer_load_dwordx4 v32, s[20:23], s50 offen offset:2048 sc1 lds
    buffer_load_dwordx4 v32, s[20:23], s50 offen offset:3072 sc1 lds
    s_add_u32 m0, s48, 81920
    s_cmp_ge_u32 s41, 2
    s_cbranch_scc1 k2_skipx_44
    buffer_load_dwordx4 v33, s[20:23], s50 offen sc1 lds
k2_skipx_44:
    s_waitcnt vmcnt(16)
    s_barrier
    s_add_u32 m0, s55, 49152
    s_add_u32 s49, s54, s69
    buffer_load_dwordx4 v28, s[24:27], s49 offen offset:0 lds
    buffer_load_dwordx4 v29, s[24:27], s49 offen offset:1024 lds
    s_add_u32 m0, s55, 51200
    s_nop 0
    buffer_load_dwordx4 v30, s[24:27], s49 offen offset:0 lds
    buffer_load_dwordx4 v31, s[24:27], s49 offen offset:1024 lds
    buffer_load_dword v35, v34, s[36:39], s60 offen sc1
    s_add_u32 m0, s55, 100352
    s_add_u32 s50, s59, s73
    buffer_load_dwordx4 v32, s[20:23], s50 offen offset:0 sc1 lds
    buffer_load_dwordx4 v32, s[20:23], s50 offen offset:1024 sc1 lds
    buffer_load_dwordx4 v32, s[20:23], s50 offen offset:2048 sc1 lds
    buffer_load_dwordx4 v32, s[20:23], s50 offen offset:3072 sc1 lds
    s_add_u32 m0, s48, 100352
    s_cmp_ge_u32 s41, 2
    s_cbranch_scc1 k2_skipx_45
    buffer_load_dwordx4 v33, s[20:23], s50 offen sc1 lds
k2_skipx_45:
    s_waitcnt vmcnt(16)
    s_barrier
    s_cmp_lg_u32 s52, s5
    s_cbranch_scc1 k2_nopub_46
    s_mov_b64 exec, 1
    buffer_store_dword v39, v38, s[36:39], s4 offen sc1
    s_mov_b64 exec, -1
k2_nopub_46:
    s_add_u32 m0, s55, 65536
    s_add_u32 s49, s54, s70
    buffer_load_dwordx4 v28, s[24:27], s49 offen offset:0 lds
    buffer_load_dwordx4 v29, s[24:27], s49 offen offset:1024 lds
    s_add_u32 m0, s55, 67584
    s_nop 0
    buffer_load_dwordx4 v30, s[24:27], s49 offen offset:0 lds
    buffer_load_dwordx4 v31, s[24:27], s49 offen offset:1024 lds
    s_add_u32 m0, s55, 118784
    s_add_u32 s50, s59, s74
    buffer_load_dwordx4 v32, s[20:23], s50 offen offset:0 sc1 lds
    buffer_load_dwordx4 v32, s[20:23], s50 offen offset:1024 sc1 lds
    buffer_load_dwordx4 v32, s[20:23], s50 offen offset:2048 sc1 lds
    buffer_load_dwordx4 v32, s[20:23], s50 offen offset:3072 sc1 lds
    s_add_u32 m0, s48, 118784
    s_cmp_ge_u32 s41, 2
    s_cbranch_scc1 k2_skipx_47
    buffer_load_dwordx4 v33, s[20:23], s50 offen sc1 lds
k2_skipx_47:
    s_waitcnt vmcnt(16)
    s_barrier
    s_add_u32 m0, s55, 16384
    s_add_u32 s49, s54, s71
    buffer_load_dwordx4 v28, s[24:27], s49 offen offset:0 lds
    buffer_load_dwordx4 v29, s[24:27], s49 offen offset:1024 lds
    s_add_u32 m0, s55, 18432
    s_nop 0
    buffer_load_dwordx4 v30, s[24:27], s49 offen offset:0 lds
    buffer_load_dwordx4 v31, s[24:27], s49 offen offset:1024 lds
    s_add_u32 m0, s55, 137216
    s_add_u32 s50, s59, s75
    buffer_load_dwordx4 v32, s[20:23], s50 offen offset:0 sc1 lds
    buffer_load_dwordx4 v32, s[20:23], s50 offen offset:1024 sc1 lds
    buffer_load_dwordx4 v32, s[20:23], s50 offen offset:2048 sc1 lds
    buffer_load_dwordx4 v32, s[20:23], s50 offen offset:3072 sc1 lds
    s_add_u32 m0, s48, 137216
    s_cmp_ge_u32 s41, 2
    s_cbranch_scc1 k2_skipx_48
    buffer_load_dwordx4 v33, s[20:23], s50 offen sc1 lds
k2_skipx_48:
    s_add_u32 s52, s52, 1
    s_cmp_lt_u32 s52, 7
    s_cbranch_scc1 k2_lloop
k2_tloop:
    s_cmp_eq_u32 s67, 7
    s_cselect_b32 s12, 5, 7
    s_add_u32 s66, s12, s52
    s_lshl_b32 s54, s66, 19
    s_mul_i32 s59, s66, 73728
    s_waitcnt vmcnt(12)
    s_barrier
    s_add_u32 m0, s55, 32768
    s_add_u32 s49, s54, s68
    buffer_load_dwordx4 v28, s[24:27], s49 offen offset:0 lds
    buffer_load_dwordx4 v29, s[24:27], s49 offen offset:1024 lds
    s_mov_b32 s61, 0
k2_chk_49:
    v_cmp_eq_u32 vcc, 1, v35
    s_nop 0
    s_bitcmp1_b32 vcc_lo, s66
    s_cbranch_scc1 k2_go_50
    buffer_load_dword v35, v34, s[36:39], s60 offen sc1
    s_add_u32 s61, s61, 1
    s_waitcnt vmcnt(0)
    s_cmp_lt_u32 s61, 100000
    s_cbranch_scc1 k2_chk_49
k2_go_50:
    s_add_u32 m0, s55, 81920
    s_add_u32 s50, s59, s72
    buffer_load_dwordx4 v32, s[20:23], s50 offen offset:0 sc1 lds
    buffer_load_dwordx4 v32, s[20:23], s50 offen offset:1024 sc1 lds
    buffer_load_dwordx4 v32, s[20:23], s50 offen offset:2048 sc1 lds
    buffer_load_dwordx4 v32, s[20:23], s50 offen offset:3072 sc1 lds
    s_add_u32 m0, s48, 81920
    s_cmp_ge_u32 s41, 2
    s_cbranch_scc1 k2_skipx_51
    buffer_load_dwordx4 v33, s[20:23], s50 offen sc1 lds
k2_skipx_51:
    s_waitcnt vmcnt(12)
    s_barrier
    s_add_u32 m0, s55, 49152
    s_add_u32 s49, s54, s69
    buffer_load_dwordx4 v28, s[24:27], s49 offen offset:0 lds
    buffer_load_dwordx4 v29, s[24:27], s49 offen offset:1024 lds
    buffer_load_dword v35, v34, s[36:39], s60 offen sc1
    s_add_u32 m0, s55, 100352
    s_add_u32 s50, s59, s73
    buffer_load_dwordx4 v32, s[20:23], s50 offen offset:0 sc1 lds
    buffer_load_dwordx4 v32, s[20:23], s50 offen offset:1024 sc1 lds
    buffer_load_dwordx4 v32, s[20:23], s50 offen offset:2048 sc1 lds
    buffer_load_dwordx4 v32, s[20:23], s50 offen offset:3072 sc1 lds
    s_add_u32 m0, s48, 100352
    s_cmp_ge_u32 s41, 2
    s_cbranch_scc1 k2_skipx_52
    buffer_load_dwordx4 v33, s[20:23], s50 offen sc1 lds
k2_skipx_52:
    s_waitcnt vmcnt(12)
    s_barrier
    s_add_u32 m0, s55, 65536
    s_add_u32 s49, s54, s70
    buffer_load_dwordx4 v28, s[24:27], s49 offen offset:0 lds
    buffer_load_dwordx4 v29, s[24:27], s49 offen offset:1024 lds
    s_add_u32 m0, s55, 118784
    s_add_u32 s50, s59, s74
    buffer_load_dwordx4 v32, s[20:23], s50 offen offset:0 sc1 lds
    buffer_load_dwordx4 v32, s[20:23], s50 offen offset:1024 sc1 lds
    buffer_load_dwordx4 v32, s[20:23], s50 offen offset:2048 sc1 lds
    buffer_load_dwordx4 v32, s[20:23], s50 offen offset:3072 sc1 lds
    s_add_u32 m0, s48, 118784
    s_cmp_ge_u32 s41, 2
    s_cbranch_scc1 k2_skipx_53
    buffer_load_dwordx4 v33, s[20:23], s50 offen sc1 lds
k2_skipx_53:
    s_waitcnt vmcnt(12)
    s_barrier
    s_add_u32 m0, s55, 16384
    s_add_u32 s49, s54, s71
    buffer_load_dwordx4 v28, s[24:27], s49 offen offset:0 lds
    buffer_load_dwordx4 v29, s[24:27], s49 offen offset:1024 lds
    s_add_u32 m0, s55, 137216
    s_add_u32 s50, s59, s75
    buffer_load_dwordx4 v32, s[20:23], s50 offen offset:0 sc1 lds
    buffer_load_dwordx4 v32, s[20:23], s50 offen offset:1024 sc1 lds
    buffer_load_dwordx4 v32, s[20:23], s50 offen offset:2048 sc1 lds
    buffer_load_dwordx4 v32, s[20:23], s50 offen offset:3072 sc1 lds
    s_add_u32 m0, s48, 137216
    s_cmp_ge_u32 s41, 2
    s_cbranch_scc1 k2_skipx_54
    buffer_load_dwordx4 v33, s[20:23], s50 offen sc1 lds
k2_skipx_54:
    s_add_u32 s52, s52, 1
    s_cmp_lt_u32 s52, 9
    s_cbranch_scc1 k2_tloop
    s_waitcnt vmcnt(12)
    s_barrier
    s_waitcnt vmcnt(6)
    s_barrier
    s_waitcnt vmcnt(0)
    s_barrier
    s_waitcnt vmcnt(0)
    s_barrier
    s_endpgm
k2_comp:
    s_setprio 1
    s_waitcnt lgkmcnt(0)
    s_barrier
    ds_read_b64_tr_b16 v[76:77], v40 offset:16384
    ds_read_b64_tr_b16 v[78:79], v40 offset:16896
    ds_read_b128 v[84:87], v42 offset:0
    ds_read_b64_tr_b16 v[80:81], v41 offset:16384
    ds_read_b64_tr_b16 v[82:83], v41 offset:16896
    ds_read_b128 v[88:91], v42 offset:1024
    ds_read_b128 v[92:95], v42 offset:2048
    ds_read_b128 v[96:99], v42 offset:3072
    ds_read_b128 v[100:103], v42 offset:4096
    ds_read_b128 v[104:107], v42 offset:5120
    ds_read_b128 v[108:111], v42 offset:6144
    ds_read_b128 v[112:115], v42 offset:7168
    ds_read_b128 v[148:151], v42 offset:8192
    s_mov_b32 s52, 0
k2_cloop:
    s_waitcnt lgkmcnt(4)
    v_mfma_f32_16x16x32_bf16 v[48:51], v[76:79], v[84:87], v[48:51]
    ds_read_b64_tr_b16 v[152:153], v40 offset:17408
    v_mfma_f32_16x16x32_bf16 v[52:55], v[80:83], v[84:87], v[52:55]
    ds_read_b64_tr_b16 v[154:155], v40 offset:17920
    v_mfma_f32_16x16x32_bf16 v[56:59], v[76:79], v[88:91], v[56:59]
    ds_read_b128 v[160:163], v43 offset:0
    v_mfma_f32_16x16x32_bf16 v[60:63], v[80:83], v[88:91], v[60:63]
    ds_read_b64_tr_b16 v[156:157], v41 offset:17408
    v_mfma_f32_16x16x32_bf16 v[64:67], v[76:79], v[92:95], v[64:67]
    ds_read_b64_tr_b16 v[158:159], v41 offset:17920
    v_mfma_f32_16x16x32_bf16 v[68:71], v[80:83], v[92:95], v[68:71]
    ds_read_b128 v[164:167], v43 offset:1024
    s_waitcnt lgkmcnt(6)
    v_mfma_f32_16x16x32_bf16 v[116:119], v[76:79], v[96:99], v[116:119]
    ds_read_b128 v[168:171], v43 offset:2048
    v_mfma_f32_16x16x32_bf16 v[120:123], v[80:83], v[96:99], v[120:123]
    ds_read_b128 v[172:175], v43 offset:3072
    v_mfma_f32_16x16x32_bf16 v[124:127], v[76:79], v[100:103], v[124:127]
    ds_read_b128 v[176:179], v43 offset:4096
    v_mfma_f32_16x16x32_bf16 v[128:131], v[80:83], v[100:103], v[128:131]
    ds_read_b128 v[180:183], v43 offset:5120
    v_mfma_f32_16x16x32_bf16 v[132:135], v[76:79], v[104:107], v[132:135]
    ds_read_b128 v[184:187], v43 offset:6144
    v_mfma_f32_16x16x32_bf16 v[136:139], v[80:83], v[104:107], v[136:139]
    ds_read_b128 v[188:191], v43 offset:7168
    v_mfma_f32_16x16x32_bf16 v[140:143], v[76:79], v[108:111], v[140:143]
    ds_read_b128 v[192:195], v43 offset:8192
    v_mfma_f32_16x16x32_bf16 v[144:147], v[80:83], v[108:111], v[144:147]
    v_mfma_f32_16x16x32_bf16 v[220:223], v[76:79], v[112:115], v[220:223]
    v_mfma_f32_16x16x32_bf16 v[224:227], v[80:83], v[112:115], v[224:227]
    v_mfma_f32_16x16x32_bf16 v[228:231], v[76:79], v[148:151], v[228:231]
    v_mfma_f32_16x16x32_bf16 v[232:235], v[80:83], v[148:151], v[232:235]
    s_waitcnt lgkmcnt(0)
    s_barrier
    v_mfma_f32_16x16x32_bf16 v[48:51], v[152:155], v[160:163], v[48:51]
    ds_read_b64_tr_b16 v[76:77], v40 offset:32768
    v_mfma_f32_16x16x32_bf16 v[52:55], v[156:159], v[160:163], v[52:55]
    ds_read_b64_tr_b16 v[78:79], v40 offset:33280
    v_mfma_f32_16x16x32_bf16 v[56:59], v[152:155], v[164:167], v[56:59]
    ds_read_b128 v[84:87], v42 offset:18432
    v_mfma_f32_16x16x32_bf16 v[60:63], v[156:159], v[164:167], v[60:63]
    ds_read_b64_tr_b16 v[80:81], v41 offset:32768
    v_mfma_f32_16x16x32_bf16 v[64:67], v[152:155], v[168:171], v[64:67]
    ds_read_b64_tr_b16 v[82:83], v41 offset:33280
    v_mfma_f32_16x16x32_bf16 v[68:71], v[156:159], v[168:171], v[68:71]
    ds_read_b128 v[88:91], v42 offset:19456
    v_mfma_f32_16x16x32_bf16 v[116:119], v[152:155], v[172:175], v[116:119]
    ds_read_b128 v[92:95], v42 offset:20480
    v_mfma_f32_16x16x32_bf16 v[120:123], v[156:159], v[172:175], v[120:123]
    ds_read_b128 v[96:99], v42 offset:21504
    v_mfma_f32_16x16x32_bf16 v[124:127], v[152:155], v[176:179], v[124:127]
    ds_read_b128 v[100:103], v42 offset:22528
    v_mfma_f32_16x16x32_bf16 v[128:131], v[156:159], v[176:179], v[128:131]
    ds_read_b128 v[104:107], v42 offset:23552
    v_mfma_f32_16x16x32_bf16 v[132:135], v[152:155], v[180:183], v[132:135]
    ds_read_b128 v[108:111], v42 offset:24576
    v_mfma_f32_16x16x32_bf16 v[136:139], v[156:159], v[180:183], v[136:139]
    ds_read_b128 v[112:115], v42 offset:25600
    v_mfma_f32_16x16x32_bf16 v[140:143], v[152:155], v[184:187], v[140:143]
    ds_read_b128 v[148:151], v42 offset:26624
    v_mfma_f32_16x16x32_bf16 v[144:147], v[156:159], v[184:187], v[144:147]
    v_mfma_f32_16x16x32_bf16 v[220:223], v[152:155], v[188:191], v[220:223]
    v_mfma_f32_16x16x32_bf16 v[224:227], v[156:159], v[188:191], v[224:227]
    v_mfma_f32_16x16x32_bf16 v[228:231], v[152:155], v[192:195], v[228:231]
    v_mfma_f32_16x16x32_bf16 v[232:235], v[156:159], v[192:195], v[232:235]
    s_waitcnt lgkmcnt(4)
    v_mfma_f32_16x16x32_bf16 v[48:51], v[76:79], v[84:87], v[48:51]
    ds_read_b64_tr_b16 v[152:153], v40 offset:33792
    v_mfma_f32_16x16x32_bf16 v[52:55], v[80:83], v[84:87], v[52:55]
    ds_read_b64_tr_b16 v[154:155], v40 offset:34304
    v_mfma_f32_16x16x32_bf16 v[56:59], v[76:79], v[88:91], v[56:59]
    ds_read_b128 v[160:163], v43 offset:18432
    v_mfma_f32_16x16x32_bf16 v[60:63], v[80:83], v[88:91], v[60:63]
    ds_read_b64_tr_b16 v[156:157], v41 offset:33792
    v_mfma_f32_16x16x32_bf16 v[64:67], v[76:79], v[92:95], v[64:67]
    ds_read_b64_tr_b16 v[158:159], v41 offset:34304
    v_mfma_f32_16x16x32_bf16 v[68:71], v[80:83], v[92:95], v[68:71]
    ds_read_b128 v[164:167], v43 offset:19456
    s_waitcnt lgkmcnt(6)
    v_mfma_f32_16x16x32_bf16 v[116:119], v[76:79], v[96:99], v[116:119]
    ds_read_b128 v[168:171], v43 offset:20480
    v_mfma_f32_16x16x32_bf16 v[120:123], v[80:83], v[96:99], v[120:123]
    ds_read_b128 v[172:175], v43 offset:21504
    v_mfma_f32_16x16x32_bf16 v[124:127], v[76:79], v[100:103], v[124:127]
    ds_read_b128 v[176:179], v43 offset:22528
    v_mfma_f32_16x16x32_bf16 v[128:131], v[80:83], v[100:103], v[128:131]
    ds_read_b128 v[180:183], v43 offset:23552
    v_mfma_f32_16x16x32_bf16 v[132:135], v[76:79], v[104:107], v[132:135]
    ds_read_b128 v[184:187], v43 offset:24576
    v_mfma_f32_16x16x32_bf16 v[136:139], v[80:83], v[104:107], v[136:139]
    ds_read_b128 v[188:191], v43 offset:25600
    v_mfma_f32_16x16x32_bf16 v[140:143], v[76:79], v[108:111], v[140:143]
    ds_read_b128 v[192:195], v43 offset:26624
    v_mfma_f32_16x16x32_bf16 v[144:147], v[80:83], v[108:111], v[144:147]
    v_mfma_f32_16x16x32_bf16 v[220:223], v[76:79], v[112:115], v[220:223]
    v_mfma_f32_16x16x32_bf16 v[224:227], v[80:83], v[112:115], v[224:227]
    v_mfma_f32_16x16x32_bf16 v[228:231], v[76:79], v[148:151], v[228:231]
    v_mfma_f32_16x16x32_bf16 v[232:235], v[80:83], v[148:151], v[232:235]
    s_waitcnt lgkmcnt(0)
    s_barrier
    v_mfma_f32_16x16x32_bf16 v[48:51], v[152:155], v[160:163], v[48:51]
    ds_read_b64_tr_b16 v[76:77], v40 offset:49152
    v_mfma_f32_16x16x32_bf16 v[52:55], v[156:159], v[160:163], v[52:55]
    ds_read_b64_tr_b16 v[78:79], v40 offset:49664
    v_mfma_f32_16x16x32_bf16 v[56:59], v[152:155], v[164:167], v[56:59]
    ds_read_b128 v[84:87], v42 offset:36864
    v_mfma_f32_16x16x32_bf16 v[60:63], v[156:159], v[164:167], v[60:63]
    ds_read_b64_tr_b16 v[80:81], v41 offset:49152
    v_mfma_f32_16x16x32_bf16 v[64:67], v[152:155], v[168:171], v[64:67]
    ds_read_b64_tr_b16 v[82:83], v41 offset:49664
    v_mfma_f32_16x16x32_bf16 v[68:71], v[156:159], v[168:171], v[68:71]
    ds_read_b128 v[88:91], v42 offset:37888
    v_mfma_f32_16x16x32_bf16 v[116:119], v[152:155], v[172:175], v[116:119]
    ds_read_b128 v[92:95], v42 offset:38912
    v_mfma_f32_16x16x32_bf16 v[120:123], v[156:159], v[172:175], v[120:123]
    ds_read_b128 v[96:99], v42 offset:39936
    v_mfma_f32_16x16x32_bf16 v[124:127], v[152:155], v[176:179], v[124:127]
    ds_read_b128 v[100:103], v42 offset:40960
    v_mfma_f32_16x16x32_bf16 v[128:131], v[156:159], v[176:179], v[128:131]
    ds_read_b128 v[104:107], v42 offset:41984
    v_mfma_f32_16x16x32_bf16 v[132:135], v[152:155], v[180:183], v[132:135]
    ds_read_b128 v[108:111], v42 offset:43008
    v_mfma_f32_16x16x32_bf16 v[136:139], v[156:159], v[180:183], v[136:139]
    ds_read_b128 v[112:115], v42 offset:44032
    v_mfma_f32_16x16x32_bf16 v[140:143], v[152:155], v[184:187], v[140:143]
    ds_read_b128 v[148:151], v42 offset:45056
    v_mfma_f32_16x16x32_bf16 v[144:147], v[156:159], v[184:187], v[144:147]
    v_mfma_f32_16x16x32_bf16 v[220:223], v[152:155], v[188:191], v[220:223]
    v_mfma_f32_16x16x32_bf16 v[224:227], v[156:159], v[188:191], v[224:227]
    v_mfma_f32_16x16x32_bf16 v[228:231], v[152:155], v[192:195], v[228:231]
    v_mfma_f32_16x16x32_bf16 v[232:235], v[156:159], v[192:195], v[232:235]
    s_cmp_eq_u32 s52, 8
    s_cbranch_scc1 k2_e2
k2_r2:
    s_waitcnt lgkmcnt(4)
    v_mfma_f32_16x16x32_bf16 v[48:51], v[76:79], v[84:87], v[48:51]
    ds_read_b64_tr_b16 v[152:153], v40 offset:50176
    v_mfma_f32_16x16x32_bf16 v[52:55], v[80:83], v[84:87], v[52:55]
    ds_read_b64_tr_b16 v[154:155], v40 offset:50688
    v_mfma_f32_16x16x32_bf16 v[56:59], v[76:79], v[88:91], v[56:59]
    ds_read_b128 v[160:163], v43 offset:36864
    v_mfma_f32_16x16x32_bf16 v[60:63], v[80:83], v[88:91], v[60:63]
    ds_read_b64_tr_b16 v[156:157], v41 offset:50176
    v_mfma_f32_16x16x32_bf16 v[64:67], v[76:79], v[92:95], v[64:67]
    ds_read_b64_tr_b16 v[158:159], v41 offset:50688
    v_mfma_f32_16x16x32_bf16 v[68:71], v[80:83], v[92:95], v[68:71]
    ds_read_b128 v[164:167], v43 offset:37888
    s_waitcnt lgkmcnt(6)
    v_mfma_f32_16x16x32_bf16 v[116:119], v[76:79], v[96:99], v[116:119]
    ds_read_b128 v[168:171], v43 offset:38912
    v_mfma_f32_16x16x32_bf16 v[120:123], v[80:83], v[96:99], v[120:123]
    ds_read_b128 v[172:175], v43 offset:39936
    v_mfma_f32_16x16x32_bf16 v[124:127], v[76:79], v[100:103], v[124:127]
    ds_read_b128 v[176:179], v43 offset:40960
    v_mfma_f32_16x16x32_bf16 v[128:131], v[80:83], v[100:103], v[128:131]
    ds_read_b128 v[180:183], v43 offset:41984
    v_mfma_f32_16x16x32_bf16 v[132:135], v[76:79], v[104:107], v[132:135]
    ds_read_b128 v[184:187], v43 offset:43008
    v_mfma_f32_16x16x32_bf16 v[136:139], v[80:83], v[104:107], v[136:139]
    ds_read_b128 v[188:191], v43 offset:44032
    v_mfma_f32_16x16x32_bf16 v[140:143], v[76:79], v[108:111], v[140:143]
    ds_read_b128 v[192:195], v43 offset:45056
    v_mfma_f32_16x16x32_bf16 v[144:147], v[80:83], v[108:111], v[144:147]
    v_mfma_f32_16x16x32_bf16 v[220:223], v[76:79], v[112:115], v[220:223]
    v_mfma_f32_16x16x32_bf16 v[224:227], v[80:83], v[112:115], v[224:227]
    v_mfma_f32_16x16x32_bf16 v[228:231], v[76:79], v[148:151], v[228:231]
    v_mfma_f32_16x16x32_bf16 v[232:235], v[80:83], v[148:151], v[232:235]
    s_waitcnt vmcnt(0) lgkmcnt(0)
    s_barrier
    v_mfma_f32_16x16x32_bf16 v[48:51], v[152:155], v[160:163], v[48:51]
    ds_read_b64_tr_b16 v[76:77], v40 offset:0
    v_mfma_f32_16x16x32_bf16 v[52:55], v[156:159], v[160:163], v[52:55]
    ds_read_b64_tr_b16 v[78:79], v40 offset:512
    v_mfma_f32_16x16x32_bf16 v[56:59], v[152:155], v[164:167], v[56:59]
    ds_read_b128 v[84:87], v42 offset:55296
    v_mfma_f32_16x16x32_bf16 v[60:63], v[156:159], v[164:167], v[60:63]
    ds_read_b64_tr_b16 v[80:81], v41 offset:0
    v_mfma_f32_16x16x32_bf16 v[64:67], v[152:155], v[168:171], v[64:67]
    ds_read_b64_tr_b16 v[82:83], v41 offset:512
    v_mfma_f32_16x16x32_bf16 v[68:71], v[156:159], v[168:171], v[68:71]
    ds_read_b128 v[88:91], v42 offset:56320
    v_mfma_f32_16x16x32_bf16 v[116:119], v[152:155], v[172:175], v[116:119]
    ds_read_b128 v[92:95], v42 offset:57344
    v_mfma_f32_16x16x32_bf16 v[120:123], v[156:159], v[172:175], v[120:123]
    ds_read_b128 v[96:99], v42 offset:58368
    v_mfma_f32_16x16x32_bf16 v[124:127], v[152:155], v[176:179], v[124:127]
    ds_read_b128 v[100:103], v42 offset:59392
    v_mfma_f32_16x16x32_bf16 v[128:131], v[156:159], v[176:179], v[128:131]
    ds_read_b128 v[104:107], v42 offset:60416
    v_mfma_f32_16x16x32_bf16 v[132:135], v[152:155], v[180:183], v[132:135]
    ds_read_b128 v[108:111], v42 offset:61440
    v_mfma_f32_16x16x32_bf16 v[136:139], v[156:159], v[180:183], v[136:139]
    ds_read_b128 v[112:115], v42 offset:62464
    v_mfma_f32_16x16x32_bf16 v[140:143], v[152:155], v[184:187], v[140:143]
    ds_read_b128 v[148:151], v42 offset:63488
    v_mfma_f32_16x16x32_bf16 v[144:147], v[156:159], v[184:187], v[144:147]
    v_mfma_f32_16x16x32_bf16 v[220:223], v[152:155], v[188:191], v[220:223]
    v_mfma_f32_16x16x32_bf16 v[224:227], v[156:159], v[188:191], v[224:227]
    v_mfma_f32_16x16x32_bf16 v[228:231], v[152:155], v[192:195], v[228:231]
    v_mfma_f32_16x16x32_bf16 v[232:235], v[156:159], v[192:195], v[232:235]
    s_cmp_eq_u32 s52, 8
    s_cbranch_scc1 k2_e3
k2_r3:
    s_waitcnt lgkmcnt(4)
    v_mfma_f32_16x16x32_bf16 v[48:51], v[76:79], v[84:87], v[48:51]
    ds_read_b64_tr_b16 v[152:153], v40 offset:1024
    v_mfma_f32_16x16x32_bf16 v[52:55], v[80:83], v[84:87], v[52:55]
    ds_read_b64_tr_b16 v[154:155], v40 offset:1536
    v_mfma_f32_16x16x32_bf16 v[56:59], v[76:79], v[88:91], v[56:59]
    ds_read_b128 v[160:163], v43 offset:55296
    v_mfma_f32_16x16x32_bf16 v[60:63], v[80:83], v[88:91], v[60:63]
    ds_read_b64_tr_b16 v[156:157], v41 offset:1024
    v_mfma_f32_16x16x32_bf16 v[64:67], v[76:79], v[92:95], v[64:67]
    ds_read_b64_tr_b16 v[158:159], v41 offset:1536
    v_mfma_f32_16x16x32_bf16 v[68:71], v[80:83], v[92:95], v[68:71]
    ds_read_b128 v[164:167], v43 offset:56320
    s_waitcnt lgkmcnt(6)
    v_mfma_f32_16x16x32_bf16 v[116:119], v[76:79], v[96:99], v[116:119]
    ds_read_b128 v[168:171], v43 offset:57344
    v_mfma_f32_16x16x32_bf16 v[120:123], v[80:83], v[96:99], v[120:123]
    ds_read_b128 v[172:175], v43 offset:58368
    v_mfma_f32_16x16x32_bf16 v[124:127], v[76:79], v[100:103], v[124:127]
    ds_read_b128 v[176:179], v43 offset:59392
    v_mfma_f32_16x16x32_bf16 v[128:131], v[80:83], v[100:103], v[128:131]
    ds_read_b128 v[180:183], v43 offset:60416
    v_mfma_f32_16x16x32_bf16 v[132:135], v[76:79], v[104:107], v[132:135]
    ds_read_b128 v[184:187], v43 offset:61440
    v_mfma_f32_16x16x32_bf16 v[136:139], v[80:83], v[104:107], v[136:139]
    ds_read_b128 v[188:191], v43 offset:62464
    v_mfma_f32_16x16x32_bf16 v[140:143], v[76:79], v[108:111], v[140:143]
    ds_read_b128 v[192:195], v43 offset:63488
    v_mfma_f32_16x16x32_bf16 v[144:147], v[80:83], v[108:111], v[144:147]
    v_mfma_f32_16x16x32_bf16 v[220:223], v[76:79], v[112:115], v[220:223]
    v_mfma_f32_16x16x32_bf16 v[224:227], v[80:83], v[112:115], v[224:227]
    v_mfma_f32_16x16x32_bf16 v[228:231], v[76:79], v[148:151], v[228:231]
    v_mfma_f32_16x16x32_bf16 v[232:235], v[80:83], v[148:151], v[232:235]
    s_waitcnt lgkmcnt(0)
    s_barrier
    v_mfma_f32_16x16x32_bf16 v[48:51], v[152:155], v[160:163], v[48:51]
    ds_read_b64_tr_b16 v[76:77], v40 offset:16384
    v_mfma_f32_16x16x32_bf16 v[52:55], v[156:159], v[160:163], v[52:55]
    ds_read_b64_tr_b16 v[78:79], v40 offset:16896
    v_mfma_f32_16x16x32_bf16 v[56:59], v[152:155], v[164:167], v[56:59]
    ds_read_b128 v[84:87], v42 offset:0
    v_mfma_f32_16x16x32_bf16 v[60:63], v[156:159], v[164:167], v[60:63]
    ds_read_b64_tr_b16 v[80:81], v41 offset:16384
    v_mfma_f32_16x16x32_bf16 v[64:67], v[152:155], v[168:171], v[64:67]
    ds_read_b64_tr_b16 v[82:83], v41 offset:16896
    v_mfma_f32_16x16x32_bf16 v[68:71], v[156:159], v[168:171], v[68:71]
    ds_read_b128 v[88:91], v42 offset:1024
    v_mfma_f32_16x16x32_bf16 v[116:119], v[152:155], v[172:175], v[116:119]
    ds_read_b128 v[92:95], v42 offset:2048
    v_mfma_f32_16x16x32_bf16 v[120:123], v[156:159], v[172:175], v[120:123]
    ds_read_b128 v[96:99], v42 offset:3072
    v_mfma_f32_16x16x32_bf16 v[124:127], v[152:155], v[176:179], v[124:127]
    ds_read_b128 v[100:103], v42 offset:4096
    v_mfma_f32_16x16x32_bf16 v[128:131], v[156:159], v[176:179], v[128:131]
    ds_read_b128 v[104:107], v42 offset:5120
    v_mfma_f32_16x16x32_bf16 v[132:135], v[152:155], v[180:183], v[132:135]
    ds_read_b128 v[108:111], v42 offset:6144
    v_mfma_f32_16x16x32_bf16 v[136:139], v[156:159], v[180:183], v[136:139]
    ds_read_b128 v[112:115], v42 offset:7168
    v_mfma_f32_16x16x32_bf16 v[140:143], v[152:155], v[184:187], v[140:143]
    ds_read_b128 v[148:151], v42 offset:8192
    v_mfma_f32_16x16x32_bf16 v[144:147], v[156:159], v[184:187], v[144:147]
    v_mfma_f32_16x16x32_bf16 v[220:223], v[152:155], v[188:191], v[220:223]
    v_mfma_f32_16x16x32_bf16 v[224:227], v[156:159], v[188:191], v[224:227]
    v_mfma_f32_16x16x32_bf16 v[228:231], v[152:155], v[192:195], v[228:231]
    v_mfma_f32_16x16x32_bf16 v[232:235], v[156:159], v[192:195], v[232:235]
    s_add_u32 s52, s52, 1
    s_cmp_lt_u32 s52, s61
    s_cbranch_scc1 k2_cloop
    s_cmp_eq_u32 s57, 0
    s_cbranch_scc1 k2_keep
    v_cvt_pk_bf16_f32 v48, v48, v49
    v_cvt_pk_bf16_f32 v49, v50, v51
    v_cvt_pk_bf16_f32 v50, v52, v53
    v_cvt_pk_bf16_f32 v51, v54, v55
    buffer_store_dwordx4 v[48:51], v44, s[20:23], s50 offen offset:0 sc1
    v_cvt_pk_bf16_f32 v56, v56, v57
    v_cvt_pk_bf16_f32 v57, v58, v59
    v_cvt_pk_bf16_f32 v58, v60, v61
    v_cvt_pk_bf16_f32 v59, v62, v63
    buffer_store_dwordx4 v[56:59], v44, s[20:23], s50 offen offset:1024 sc1
    v_cvt_pk_bf16_f32 v64, v64, v65
    v_cvt_pk_bf16_f32 v65, v66, v67
    v_cvt_pk_bf16_f32 v66, v68, v69
    v_cvt_pk_bf16_f32 v67, v70, v71
    buffer_store_dwordx4 v[64:67], v44, s[20:23], s50 offen offset:2048 sc1
    v_cvt_pk_bf16_f32 v116, v116, v117
    v_cvt_pk_bf16_f32 v117, v118, v119
    v_cvt_pk_bf16_f32 v118, v120, v121
    v_cvt_pk_bf16_f32 v119, v122, v123
    buffer_store_dwordx4 v[116:119], v44, s[20:23], s50 offen offset:3072 sc1
    s_add_u32 s50, s50, 4096
    v_cvt_pk_bf16_f32 v124, v124, v125
    v_cvt_pk_bf16_f32 v125, v126, v127
    v_cvt_pk_bf16_f32 v126, v128, v129
    v_cvt_pk_bf16_f32 v127, v130, v131
    buffer_store_dwordx4 v[124:127], v44, s[20:23], s50 offen offset:0 sc1
    v_cvt_pk_bf16_f32 v132, v132, v133
    v_cvt_pk_bf16_f32 v133, v134, v135
    v_cvt_pk_bf16_f32 v134, v136, v137
    v_cvt_pk_bf16_f32 v135, v138, v139
    buffer_store_dwordx4 v[132:135], v44, s[20:23], s50 offen offset:1024 sc1
    v_cvt_pk_bf16_f32 v140, v140, v141
    v_cvt_pk_bf16_f32 v141, v142, v143
    v_cvt_pk_bf16_f32 v142, v144, v145
    v_cvt_pk_bf16_f32 v143, v146, v147
    buffer_store_dwordx4 v[140:143], v44, s[20:23], s50 offen offset:2048 sc1
    v_cvt_pk_bf16_f32 v220, v220, v221
    v_cvt_pk_bf16_f32 v221, v222, v223
    v_cvt_pk_bf16_f32 v222, v224, v225
    v_cvt_pk_bf16_f32 v223, v226, v227
    buffer_store_dwordx4 v[220:223], v44, s[20:23], s50 offen offset:3072 sc1
    s_add_u32 s50, s50, 4096
    v_cvt_pk_bf16_f32 v228, v228, v229
    v_cvt_pk_bf16_f32 v229, v230, v231
    v_cvt_pk_bf16_f32 v230, v232, v233
    v_cvt_pk_bf16_f32 v231, v234, v235
    buffer_store_dwordx4 v[228:231], v44, s[20:23], s50 offen offset:0 sc1
    s_barrier
    s_barrier
    s_barrier
    v_mov_b32 v47, 1
    s_mov_b64 exec, 1
    s_waitcnt vmcnt(0)
    buffer_store_dword v47, v46, s[36:39], s53 offen sc1
    s_mov_b64 exec, -1
    s_barrier
    s_barrier
    s_barrier
    s_barrier
    s_barrier
    s_endpgm
k2_e2:
    buffer_load_dword v47, v46, s[36:39], s53 offen sc1
    s_branch k2_r2
k2_e3:
    s_waitcnt vmcnt(0)
    v_cmp_eq_u32 vcc, 1, v47
    s_cbranch_vccz k2_r3
    buffer_load_dwordx4 v[196:199], v44, s[20:23], s50 offen offset:0 sc1
    buffer_load_dwordx4 v[200:203], v44, s[20:23], s50 offen offset:1024 sc1
    buffer_load_dwordx4 v[204:207], v44, s[20:23], s50 offen offset:2048 sc1
    buffer_load_dwordx4 v[208:211], v44, s[20:23], s50 offen offset:3072 sc1
    s_add_u32 s50, s50, 4096
    buffer_load_dwordx4 v[212:215], v44, s[20:23], s50 offen offset:0 sc1
    buffer_load_dwordx4 v[216:219], v44, s[20:23], s50 offen offset:1024 sc1
    buffer_load_dwordx4 v[236:239], v44, s[20:23], s50 offen offset:2048 sc1
    buffer_load_dwordx4 v[240:243], v44, s[20:23], s50 offen offset:3072 sc1
    s_add_u32 s50, s50, 4096
    buffer_load_dwordx4 v[244:247], v44, s[20:23], s50 offen offset:0 sc1
    s_mov_b32 s51, 1
    s_branch k2_r3
k2_keep:
    s_mov_b32 s52, 0
    s_cmp_eq_u32 s51, 1
    s_cbranch_scc1 k2_have
k2_poll:
    buffer_load_dword v47, v46, s[36:39], s53 offen sc1
    s_add_u32 s52, s52, 1
    s_waitcnt vmcnt(0)
    v_cmp_eq_u32 vcc, 1, v47
    s_cbranch_vccnz k2_got
    s_cmp_lt_u32 s52, 100000
    s_cbranch_scc1 k2_poll
k2_got:
    buffer_load_dwordx4 v[196:199], v44, s[20:23], s50 offen offset:0 sc1
    buffer_load_dwordx4 v[200:203], v44, s[20:23], s50 offen offset:1024 sc1
    buffer_load_dwordx4 v[204:207], v44, s[20:23], s50 offen offset:2048 sc1
    buffer_load_dwordx4 v[208:211], v44, s[20:23], s50 offen offset:3072 sc1
    s_add_u32 s50, s50, 4096
    buffer_load_dwordx4 v[212:215], v44, s[20:23], s50 offen offset:0 sc1
    buffer_load_dwordx4 v[216:219], v44, s[20:23], s50 offen offset:1024 sc1
    buffer_load_dwordx4 v[236:239], v44, s[20:23], s50 offen offset:2048 sc1
    buffer_load_dwordx4 v[240:243], v44, s[20:23], s50 offen offset:3072 sc1
    s_add_u32 s50, s50, 4096
    buffer_load_dwordx4 v[244:247], v44, s[20:23], s50 offen offset:0 sc1
k2_have:
    s_mul_i32 s3, s44, 589824
    s_add_u32 s28, s10, s3
    s_addc_u32 s29, s11, 0
    s_mov_b32 s30, 589824
    s_mov_b32 s31, 0x20000
    v_and_b32 v28, 15, v0
    v_lshlrev_b32 v28, 12, v28
    v_lshl_add_u32 v28, v45, 4, v28
    s_lshl_b32 s3, s43, 11
    s_lshl_b32 s4, s45, 7
    s_add_u32 s3, s3, s4
    s_lshl_b32 s4, s58, 6
    s_add_u32 s3, s3, s4
    s_waitcnt vmcnt(8)
    v_lshlrev_b32 v32, 16, v196
    v_and_b32 v33, 0xffff0000, v196
    v_lshlrev_b32 v34, 16, v197
    v_and_b32 v35, 0xffff0000, v197
    v_lshlrev_b32 v36, 16, v198
    v_and_b32 v37, 0xffff0000, v198
    v_lshlrev_b32 v38, 16, v199
    v_and_b32 v39, 0xffff0000, v199
    v_pk_add_f32 v[48:49], v[48:49], v[32:33]
    v_pk_add_f32 v[50:51], v[50:51], v[34:35]
    v_pk_add_f32 v[52:53], v[52:53], v[36:37]
    v_pk_add_f32 v[54:55], v[54:55], v[38:39]
    v_cvt_pk_bf16_f32 v48, v48, v49
    v_cvt_pk_bf16_f32 v49, v50, v51
    v_cvt_pk_bf16_f32 v50, v52, v53
    v_cvt_pk_bf16_f32 v51, v54, v55
    s_nop 0
    v_permlane32_swap_b32 v48, v50
    v_permlane32_swap_b32 v49, v51
    s_nop 0
    v_permlane16_swap_b32 v48, v50
    v_permlane16_swap_b32 v49, v51
    buffer_store_dwordx4 v[48:51], v28, s[28:31], s3 offen sc0 sc1
    s_add_u32 s3, s3, 65536
    s_waitcnt vmcnt(8)
    v_lshlrev_b32 v32, 16, v200
    v_and_b32 v33, 0xffff0000, v200
    v_lshlrev_b32 v34, 16, v201
    v_and_b32 v35, 0xffff0000, v201
    v_lshlrev_b32 v36, 16, v202
    v_and_b32 v37, 0xffff0000, v202
    v_lshlrev_b32 v38, 16, v203
    v_and_b32 v39, 0xffff0000, v203
    v_pk_add_f32 v[56:57], v[56:57], v[32:33]
    v_pk_add_f32 v[58:59], v[58:59], v[34:35]
    v_pk_add_f32 v[60:61], v[60:61], v[36:37]
    v_pk_add_f32 v[62:63], v[62:63], v[38:39]
    v_cvt_pk_bf16_f32 v56, v56, v57
    v_cvt_pk_bf16_f32 v57, v58, v59
    v_cvt_pk_bf16_f32 v58, v60, v61
    v_cvt_pk_bf16_f32 v59, v62, v63
    s_nop 0
    v_permlane32_swap_b32 v56, v58
    v_permlane32_swap_b32 v57, v59
    s_nop 0
    v_permlane16_swap_b32 v56, v58
    v_permlane16_swap_b32 v57, v59
    buffer_store_dwordx4 v[56:59], v28, s[28:31], s3 offen sc0 sc1
    s_add_u32 s3, s3, 65536
    s_waitcnt vmcnt(8)
    v_lshlrev_b32 v32, 16, v204
    v_and_b32 v33, 0xffff0000, v204
    v_lshlrev_b32 v34, 16, v205
    v_and_b32 v35, 0xffff0000, v205
    v_lshlrev_b32 v36, 16, v206
    v_and_b32 v37, 0xffff0000, v206
    v_lshlrev_b32 v38, 16, v207
    v_and_b32 v39, 0xffff0000, v207
    v_pk_add_f32 v[64:65], v[64:65], v[32:33]
    v_pk_add_f32 v[66:67], v[66:67], v[34:35]
    v_pk_add_f32 v[68:69], v[68:69], v[36:37]
    v_pk_add_f32 v[70:71], v[70:71], v[38:39]
    v_cvt_pk_bf16_f32 v64, v64, v65
    v_cvt_pk_bf16_f32 v65, v66, v67
    v_cvt_pk_bf16_f32 v66, v68, v69
    v_cvt_pk_bf16_f32 v67, v70, v71
    s_nop 0
    v_permlane32_swap_b32 v64, v66
    v_permlane32_swap_b32 v65, v67
    s_nop 0
    v_permlane16_swap_b32 v64, v66
    v_permlane16_swap_b32 v65, v67
    buffer_store_dwordx4 v[64:67], v28, s[28:31], s3 offen sc0 sc1
    s_add_u32 s3, s3, 65536
    s_waitcnt vmcnt(8)
    v_lshlrev_b32 v32, 16, v208
    v_and_b32 v33, 0xffff0000, v208
    v_lshlrev_b32 v34, 16, v209
    v_and_b32 v35, 0xffff0000, v209
    v_lshlrev_b32 v36, 16, v210
    v_and_b32 v37, 0xffff0000, v210
    v_lshlrev_b32 v38, 16, v211
    v_and_b32 v39, 0xffff0000, v211
    v_pk_add_f32 v[116:117], v[116:117], v[32:33]
    v_pk_add_f32 v[118:119], v[118:119], v[34:35]
    v_pk_add_f32 v[120:121], v[120:121], v[36:37]
    v_pk_add_f32 v[122:123], v[122:123], v[38:39]
    v_cvt_pk_bf16_f32 v116, v116, v117
    v_cvt_pk_bf16_f32 v117, v118, v119
    v_cvt_pk_bf16_f32 v118, v120, v121
    v_cvt_pk_bf16_f32 v119, v122, v123
    s_nop 0
    v_permlane32_swap_b32 v116, v118
    v_permlane32_swap_b32 v117, v119
    s_nop 0
    v_permlane16_swap_b32 v116, v118
    v_permlane16_swap_b32 v117, v119
    buffer_store_dwordx4 v[116:119], v28, s[28:31], s3 offen sc0 sc1
    s_add_u32 s3, s3, 65536
    s_waitcnt vmcnt(8)
    v_lshlrev_b32 v32, 16, v212
    v_and_b32 v33, 0xffff0000, v212
    v_lshlrev_b32 v34, 16, v213
    v_and_b32 v35, 0xffff0000, v213
    v_lshlrev_b32 v36, 16, v214
    v_and_b32 v37, 0xffff0000, v214
    v_lshlrev_b32 v38, 16, v215
    v_and_b32 v39, 0xffff0000, v215
    v_pk_add_f32 v[124:125], v[124:125], v[32:33]
    v_pk_add_f32 v[126:127], v[126:127], v[34:35]
    v_pk_add_f32 v[128:129], v[128:129], v[36:37]
    v_pk_add_f32 v[130:131], v[130:131], v[38:39]
    v_cvt_pk_bf16_f32 v124, v124, v125
    v_cvt_pk_bf16_f32 v125, v126, v127
    v_cvt_pk_bf16_f32 v126, v128, v129
    v_cvt_pk_bf16_f32 v127, v130, v131
    s_nop 0
    v_permlane32_swap_b32 v124, v126
    v_permlane32_swap_b32 v125, v127
    s_nop 0
    v_permlane16_swap_b32 v124, v126
    v_permlane16_swap_b32 v125, v127
    buffer_store_dwordx4 v[124:127], v28, s[28:31], s3 offen sc0 sc1
    s_add_u32 s3, s3, 65536
    s_waitcnt vmcnt(8)
    v_lshlrev_b32 v32, 16, v216
    v_and_b32 v33, 0xffff0000, v216
    v_lshlrev_b32 v34, 16, v217
    v_and_b32 v35, 0xffff0000, v217
    v_lshlrev_b32 v36, 16, v218
    v_and_b32 v37, 0xffff0000, v218
    v_lshlrev_b32 v38, 16, v219
    v_and_b32 v39, 0xffff0000, v219
    v_pk_add_f32 v[132:133], v[132:133], v[32:33]
    v_pk_add_f32 v[134:135], v[134:135], v[34:35]
    v_pk_add_f32 v[136:137], v[136:137], v[36:37]
    v_pk_add_f32 v[138:139], v[138:139], v[38:39]
    v_cvt_pk_bf16_f32 v132, v132, v133
    v_cvt_pk_bf16_f32 v133, v134, v135
    v_cvt_pk_bf16_f32 v134, v136, v137
    v_cvt_pk_bf16_f32 v135, v138, v139
    s_nop 0
    v_permlane32_swap_b32 v132, v134
    v_permlane32_swap_b32 v133, v135
    s_nop 0
    v_permlane16_swap_b32 v132, v134
    v_permlane16_swap_b32 v133, v135
    buffer_store_dwordx4 v[132:135], v28, s[28:31], s3 offen sc0 sc1
    s_add_u32 s3, s3, 65536
    s_waitcnt vmcnt(8)
    v_lshlrev_b32 v32, 16, v236
    v_and_b32 v33, 0xffff0000, v236
    v_lshlrev_b32 v34, 16, v237
    v_and_b32 v35, 0xffff0000, v237
    v_lshlrev_b32 v36, 16, v238
    v_and_b32 v37, 0xffff0000, v238
    v_lshlrev_b32 v38, 16, v239
    v_and_b32 v39, 0xffff0000, v239
    v_pk_add_f32 v[140:141], v[140:141], v[32:33]
    v_pk_add_f32 v[142:143], v[142:143], v[34:35]
    v_pk_add_f32 v[144:145], v[144:145], v[36:37]
    v_pk_add_f32 v[146:147], v[146:147], v[38:39]
    v_cvt_pk_bf16_f32 v140, v140, v141
    v_cvt_pk_bf16_f32 v141, v142, v143
    v_cvt_pk_bf16_f32 v142, v144, v145
    v_cvt_pk_bf16_f32 v143, v146, v147
    s_nop 0
    v_permlane32_swap_b32 v140, v142
    v_permlane32_swap_b32 v141, v143
    s_nop 0
    v_permlane16_swap_b32 v140, v142
    v_permlane16_swap_b32 v141, v143
    buffer_store_dwordx4 v[140:143], v28, s[28:31], s3 offen sc0 sc1
    s_add_u32 s3, s3, 65536
    s_waitcnt vmcnt(8)
    v_lshlrev_b32 v32, 16, v240
    v_and_b32 v33, 0xffff0000, v240
    v_lshlrev_b32 v34, 16, v241
    v_and_b32 v35, 0xffff0000, v241
    v_lshlrev_b32 v36, 16, v242
    v_and_b32 v37, 0xffff0000, v242
    v_lshlrev_b32 v38, 16, v243
    v_and_b32 v39, 0xffff0000, v243
    v_pk_add_f32 v[220:221], v[220:221], v[32:33]
    v_pk_add_f32 v[222:223], v[222:223], v[34:35]
    v_pk_add_f32 v[224:225], v[224:225], v[36:37]
    v_pk_add_f32 v[226:227], v[226:227], v[38:39]
    v_cvt_pk_bf16_f32 v220, v220, v221
    v_cvt_pk_bf16_f32 v221, v222, v223
    v_cvt_pk_bf16_f32 v222, v224, v225
    v_cvt_pk_bf16_f32 v223, v226, v227
    s_nop 0
    v_permlane32_swap_b32 v220, v222
    v_permlane32_swap_b32 v221, v223
    s_nop 0
    v_permlane16_swap_b32 v220, v222
    v_permlane16_swap_b32 v221, v223
    buffer_store_dwordx4 v[220:223], v28, s[28:31], s3 offen sc0 sc1
    s_add_u32 s3, s3, 65536
    s_waitcnt vmcnt(8)
    v_lshlrev_b32 v32, 16, v244
    v_and_b32 v33, 0xffff0000, v244
    v_lshlrev_b32 v34, 16, v245
    v_and_b32 v35, 0xffff0000, v245
    v_lshlrev_b32 v36, 16, v246
    v_and_b32 v37, 0xffff0000, v246
    v_lshlrev_b32 v38, 16, v247
    v_and_b32 v39, 0xffff0000, v247
    v_pk_add_f32 v[228:229], v[228:229], v[32:33]
    v_pk_add_f32 v[230:231], v[230:231], v[34:35]
    v_pk_add_f32 v[232:233], v[232:233], v[36:37]
    v_pk_add_f32 v[234:235], v[234:235], v[38:39]
    v_cvt_pk_bf16_f32 v228, v228, v229
    v_cvt_pk_bf16_f32 v229, v230, v231
    v_cvt_pk_bf16_f32 v230, v232, v233
    v_cvt_pk_bf16_f32 v231, v234, v235
    s_nop 0
    v_permlane32_swap_b32 v228, v230
    v_permlane32_swap_b32 v229, v231
    s_nop 0
    v_permlane16_swap_b32 v228, v230
    v_permlane16_swap_b32 v229, v231
    buffer_store_dwordx4 v[228:231], v28, s[28:31], s3 offen sc0 sc1
    s_add_u32 s3, s3, 65536
k1_end:
    s_endpgm
.section .rodata,"a"
.p2align 6
.amdhsa_kernel concat_heads__mha_block_cached__mha_block_cached__near_ridge_kernel
  .amdhsa_next_free_vgpr 256
  .amdhsa_next_free_sgpr 102
  .amdhsa_accum_offset 256
  .amdhsa_group_segment_fixed_size 0
  .amdhsa_kernarg_size 104
  .amdhsa_user_sgpr_count 2
  .amdhsa_user_sgpr_kernarg_segment_ptr 1
  .amdhsa_system_sgpr_workgroup_id_x 1
.end_amdhsa_kernel
```
